```python
import torch

def _softmax(x, axis=-1):
    return torch.softmax(x, dim=axis)
def _gelu(x):
    return torch.nn.functional.gelu(x, approximate="tanh")
def _silu(x):
    return torch.nn.functional.silu(x)
def _sigmoid(x):
    return torch.sigmoid(x)
def _layernorm(x, axis=-1, eps=1e-5):
    m = x.mean(dim=axis, keepdim=True)
    v = x.var(dim=axis, keepdim=True, unbiased=False)
    return (x - m) / torch.sqrt(v + eps)
def _scatter_add(tgt, idx, src, axis=0):
    return tgt.clone().index_add_(axis, idx, src)
def _segment_sum(src, seg, n):
    out = torch.zeros((n,) + src.shape[1:], dtype=src.dtype)
    return out.index_add_(0, seg, src)
def _pad(x, pw):
    flat = tuple(v for pair in reversed(pw) for v in pair)
    return torch.nn.functional.pad(x, flat)

kernel_name = 'recurrent_scan__sliding_block__glu_gated_swiglu__prompt'

def setup_inputs():

    _w = (lambda a: (lambda t: t.to(torch.bfloat16) if t.is_floating_point() else t)(torch.as_tensor(a)))
    def _A_setup():
        B, S, D = 1, 2048, 448
        return {
            "x": _w((lambda *s: torch.randn(*s, dtype=torch.bfloat16) * 0.05)(B, S, D)),
            "wqkv": _w((lambda *s: torch.randn(*s, dtype=torch.bfloat16) * 0.2)(D, 3 * D)),
            "wo": _w((lambda *s: torch.randn(*s, dtype=torch.bfloat16) * 0.2)(D, D)),
        }
    _A_in = _A_setup()

    def _B_setup():
        B, S, D, F = 1, 2048, 448, 1792
        return {
            "x": _w((lambda *s: torch.randn(*s, dtype=torch.bfloat16) * 0.05)(B, S, D)),
            "w1": _w((lambda *s: torch.randn(*s, dtype=torch.bfloat16) * 0.1)(D, F) * (2.0 / D) ** 0.5),
            "w3": _w((lambda *s: torch.randn(*s, dtype=torch.bfloat16) * 0.1)(D, F) * (2.0 / D) ** 0.5),
            "w2": _w((lambda *s: torch.randn(*s, dtype=torch.bfloat16) * 0.1)(F, D) * (2.0 / F) ** 0.5),
        }
    _B_in = _B_setup()

    return {
        "A_x": _A_in["x"],
        "A_wqkv": _A_in["wqkv"],
        "A_wo": _A_in["wo"],
        "B_x": _B_in["x"],
        "B_w1": _B_in["w1"],
        "B_w3": _B_in["w3"],
        "B_w2": _B_in["w2"],
    }

def reference(A_x, A_wqkv, A_wo, B_x, B_w1, B_w3, B_w2):
    def _A_ref(x, wqkv, wo):
        B, S, D = x.shape
        H = 16; Dh = D // H; W = 256
        qkv = (lambda x, *d: x.permute(*d))((x @ wqkv).reshape(B, S, 3, H, Dh), 2, 0, 3, 1, 4)
        q, k, v = qkv[0], qkv[1], qkv[2]
        scores = torch.einsum("bhqd,bhkd->bhqk", q, k) * (Dh ** -0.5)
        idx = torch.arange(S)
        mask = (idx[:, None] - idx[None, :] >= 0) & (idx[:, None] - idx[None, :] < W)
        scores = torch.where(mask[None, None], scores, -1e9)
        p = _softmax(scores, axis=-1)
        o = torch.einsum("bhqk,bhkd->bhqd", p, v)
        return (lambda x, *d: x.permute(*d))(o, 0, 2, 1, 3).reshape(B, S, D) @ wo

    def _B_ref(x, w1, w3, w2):
        gate = torch.einsum("bsd,df->bsf", x, w1)
        up = torch.einsum("bsd,df->bsf", x, w3)
        h = _silu(gate) * up
        out = torch.einsum("bsf,fd->bsd", h, w2)
        return out

    x = A_x
    xn = _layernorm(x, axis=-1)
    s = _A_ref(xn, A_wqkv, A_wo)
    g = _silu(_B_ref(xn, B_w1, B_w3, B_w2))
    return x + s * g
```

```asm
; @launch grid=(256,1,1) block=(512,1,1) lds=163840
.amdgcn_target "amdgcn-amd-amdhsa--gfx950"
.text
.globl recurrent_scan__sliding_block__glu_gated_swiglu__prompt_kernel
.p2align 8
.type recurrent_scan__sliding_block__glu_gated_swiglu__prompt_kernel,@function
recurrent_scan__sliding_block__glu_gated_swiglu__prompt_kernel:
    s_cmp_ge_u32 s2, 256
    s_cbranch_scc1 L_end
    s_load_dwordx2 s[36:37], s[0:1], 0
    s_load_dwordx2 s[44:45], s[0:1], 8
    s_load_dwordx2 s[56:57], s[0:1], 32
    s_load_dwordx2 s[60:61], s[0:1], 40
    s_load_dwordx2 s[40:41], s[0:1], 72
    v_readfirstlane_b32 s3, v0
    v_and_b32 v1, 63, v0
    s_getpc_b64 s[94:95]
L_pc_1:
    v_lshlrev_b32 v120, 7, v0
    v_mov_b32 v123, s95
    v_add_co_u32 v122, vcc, s94, v120
    v_addc_co_u32 v123, vcc, 0, v123, vcc
    v_cmp_gt_u32 vcc, L_code_end-L_pc_1, v120
    s_nop 0
    s_and_saveexec_b64 s[94:95], vcc
    s_cbranch_execz L_pc_1_x
    global_load_dword v120, v[122:123], off
L_pc_1_x:
    s_mov_b64 exec, -1
    s_and_b32 s4, s2, 1
    s_lshl_b32 s4, s4, 3
    s_bfe_u32 s94, s2, 0x30003
    s_add_u32 s4, s4, s94
    s_xor_b32 s4, s4, 8
    v_lshrrev_b32 v224, 3, v0
    v_and_b32 v225, 7, v0
    v_bfe_u32 v228, v0, 4, 3
    v_mul_u32_u24 v6, 896, v224
    v_xor_b32 v228, v228, v225
    s_lshl_b32 s6, s3, 4
    s_lshr_b32 s3, s3, 6
    v_lshl_add_u32 v7, v228, 4, v6
    s_mul_i32 s14, s4, 114688
    s_add_u32 s15, s14, 57344
    s_waitcnt lgkmcnt(0)
    s_and_b32 s37, s37, 0xffff
    s_mov_b32 s38, 1835008
    s_mov_b32 s39, 0x20000
    s_add_u32 m0, s6, 0
    s_nop 0
    buffer_load_dwordx4 v7, s[36:39], s14 offen lds
    s_add_u32 m0, s6, 8192
    s_nop 0
    buffer_load_dwordx4 v7, s[36:39], s15 offen lds
    s_lshr_b32 s5, s2, 6
    s_lshl_b32 s5, s5, 2
    s_bfe_u32 s94, s2, 0x20001
    s_add_u32 s5, s5, s94
    v_lshrrev_b32 v226, 2, v0
    v_and_b32 v226, 4, v226
    v_xor_b32 v226, v226, v225
    v_lshrrev_b32 v228, 2, v226
    v_sub_u32 v228, v226, v228
    v_mul_u32_u24 v3, 2688, v224
    v_lshl_add_u32 v3, v228, 4, v3
    s_mul_i32 s94, s5, 3
    s_sub_u32 s94, s94, 24
    s_cmp_ge_u32 s5, 12
    s_cselect_b32 s79, s94, s5
    s_mul_i32 s8, s79, 112
    s_and_b32 s45, s45, 0xffff
    s_mov_b32 s46, 1204224
    s_mov_b32 s47, 0x20000
    s_add_u32 m0, s6, 65536
    s_nop 0
    buffer_load_dwordx4 v3, s[44:47], s8 offen lds
    s_and_b32 s57, s57, 0xffff
    s_mov_b32 s58, 1605632
    s_mov_b32 s59, 0x20000
    s_and_b32 s61, s61, 0xffff
    s_mov_b32 s62, 1605632
    s_mov_b32 s63, 0x20000
    v_mul_u32_u24 v4, 3584, v224
    s_lshl_b32 s96, s5, 7
    s_cmp_ge_u32 s5, 12
    s_cselect_b64 vcc, -1, 0
    v_lshl_add_u32 v4, v226, 4, v4
    s_cselect_b32 s9, s8, s96
    s_cselect_b32 s95, 112, 0
    s_cselect_b64 s[48:49], s[44:45], s[56:57]
    s_cselect_b64 s[52:53], s[44:45], s[60:61]
    s_cselect_b64 s[50:51], s[46:47], s[58:59]
    s_cselect_b64 s[54:55], s[46:47], s[58:59]
    v_cndmask_b32 v5, v4, v3, vcc
    s_mov_b32 s13, 229376
    s_cselect_b32 s13, 172032, s13
    s_add_u32 s9, s9, s95
    s_add_u32 s10, s9, s95
    s_add_u32 m0, s6, 73728
    s_nop 0
    buffer_load_dwordx4 v5, s[48:51], s9 offen lds
    s_add_u32 m0, s6, 81920
    s_nop 0
    buffer_load_dwordx4 v5, s[52:55], s10 offen lds
    s_load_dword s7, s[40:41], 32768
    s_load_dwordx2 s[64:65], s[0:1], 48
    s_load_dwordx2 s[68:69], s[0:1], 16
    s_add_u32 s11, s96, 1536
    s_mov_b32 s12, s11
    s_add_u32 m0, s6, 16384
    s_add_u32 s14, s14, 128
    buffer_load_dwordx4 v7, s[36:39], s14 offen lds
    s_add_u32 m0, s6, 24576
    s_add_u32 s15, s15, 128
    buffer_load_dwordx4 v7, s[36:39], s15 offen lds
    s_add_u32 m0, s6, 90112
    s_add_u32 s8, s8, 172032
    buffer_load_dwordx4 v3, s[44:47], s8 offen lds
    s_add_u32 m0, s6, 98304
    s_add_u32 s9, s9, s13
    buffer_load_dwordx4 v5, s[48:51], s9 offen lds
    s_add_u32 m0, s6, 106496
    s_add_u32 s10, s10, s13
    buffer_load_dwordx4 v5, s[52:55], s10 offen lds
    v_lshl_add_u32 v6, v226, 4, v6
    s_cmp_ge_u32 s5, 12
    s_cselect_b32 s94, 3, 1
    s_cmp_lt_u32 s3, s94
    s_cselect_b32 s97, 1, 0
    s_cselect_b64 s[34:35], s[46:47], s[58:59]
    s_movk_i32 s95, 3584
    s_cselect_b32 s95, 2688, s95
    s_bitcmp1_b32 s3, 0
    s_cselect_b64 s[32:33], s[56:57], s[60:61]
    s_cmp_eq_u32 s97, 1
    s_cselect_b64 s[32:33], s[44:45], s[32:33]
    s_cmp_eq_u32 s3, 1
    s_cselect_b32 s96, s9, s8
    s_cmp_eq_u32 s3, 2
    s_cselect_b32 s96, s10, s96
    s_sub_u32 s96, s96, s13
    s_cmp_eq_u32 s3, 0
    s_cselect_b32 s94, 172032, 0
    s_cselect_b32 s96, s8, s96
    s_sub_u32 s96, s96, s94
    s_cmp_ge_u32 s3, 3
    s_cselect_b32 s96, s11, s96
    s_mul_i32 s99, s95, 7
    s_mul_i32 s98, s99, s4
    s_lshl_b32 s98, s98, 2
    s_add_u32 s98, s98, s96
    v_lshrrev_b32 v232, 3, v1
    v_lshrrev_b32 v243, 2, v225
    v_and_b32 v243, s97, v243
    v_sub_u32 v243, v225, v243
    v_mul_u32_u24 v242, s95, v232
    v_lshl_add_u32 v242, v243, 4, v242
    v_cmp_gt_u32 vcc, 7, v232
    v_mov_b32 v231, 0x7ff00000
    s_nop 0
    v_cndmask_b32 v242, v231, v242, vcc
    v_mov_b32 v243, v242
    s_cmp_lt_u32 s3, 5
    s_cbranch_scc1 L_e_src
    s_lshl_b32 s94, s4, 4
    s_add_u32 s94, s94, s5
    s_lshl_b32 s94, s94, 1
    s_add_u32 s94, s94, s3
    s_sub_u32 s94, s94, 5
    s_mul_i32 s98, s94, 3584
    s_movk_i32 s99, 256
    s_mov_b64 s[32:33], s[36:37]
    s_cmp_eq_u32 s3, 7
    s_cselect_b32 s34, 0, s38
    v_lshrrev_b32 v232, 4, v1
    v_and_b32 v243, 15, v1
    v_mul_u32_u24 v242, 896, v232
    v_cmp_gt_u32 vcc, 8, v243
    v_lshl_add_u32 v242, v243, 4, v242
    s_nop 0
    v_cndmask_b32 v243, v231, v242, vcc
L_e_src:
    s_lshr_b32 s94, s3, 2
    s_and_b32 s95, s3, 3
    s_cmp_eq_u32 s94, 0
    s_cselect_b32 s84, 0, -1
    s_mov_b32 s85, 0
    s_lshl_b32 s96, s4, 2
    s_add_u32 s96, s96, s95
    s_lshl_b32 s88, s96, 9
    s_add_u32 s88, s88, 65536
    s_mul_i32 s82, s96, 114688
    s_mul_i32 s76, s96, 98304
    s_mul_i32 s96, s94, 57344
    s_add_u32 s82, s82, s96
    s_lshl_b32 s96, s5, 10
    s_add_u32 s82, s82, s96
    s_add_u32 s82, s82, 8388608
    s_lshl_b32 s96, s94, 11
    s_add_u32 s76, s76, s96
    s_lshl_b32 s96, s79, 12
    s_add_u32 s76, s76, s96
    s_add_u32 s76, s76, 1048576
    s_add_u32 s77, s76, 4096
    s_add_u32 s78, s76, 8192
    s_add_u32 s80, s79, 1
    s_add_u32 s81, s79, 2
    s_bitcmp1_b32 s79, 3
    s_cselect_b32 s79, 0, 0x3f80
    s_bitcmp1_b32 s80, 3
    s_cselect_b32 s80, 0, 0x3f80
    s_bitcmp1_b32 s81, 3
    s_cselect_b32 s81, 0, 0x3f80
    s_lshl_b32 s83, s4, 8
    s_lshl_b32 s96, s5, 2
    s_add_u32 s83, s83, s96
    s_lshl_b32 s86, s5, 14
    s_add_u32 s86, s86, s6
    s_add_u32 s86, s86, 131072
    s_add_u32 s87, s86, 8192
    s_cmp_lt_u32 s3, 2
    s_cselect_b32 s87, s87, 33554432
    s_and_b32 s96, s2, 7
    s_lshr_b32 s97, s2, 3
    s_lshl_b32 s92, s96, 1
    s_lshl_b32 s93, s96, 2
    s_and_b32 s96, s97, 1
    s_add_u32 s92, s92, s96
    s_lshr_b32 s91, s97, 1
    s_lshl_b32 s89, s93, 1
    s_mov_b32 vcc_lo, 1480138240
    s_mov_b32 vcc_hi, 3332935539
    s_lshr_b64 vcc, vcc, s89
    s_and_b32 s96, vcc_lo, 0xff
    s_mov_b32 vcc_lo, 455023390
    s_mov_b32 vcc_hi, 438180124
    s_lshr_b64 vcc, vcc, s89
    s_and_b32 s90, vcc_lo, 0xff
    s_add_u32 s96, s96, s97
    s_min_u32 s96, s96, 223
    s_mul_i32 s93, s96, 9363
    s_lshr_b32 s93, s93, 16
    s_mul_i32 s101, s93, 7
    s_sub_u32 s101, s96, s101
    s_cmp_lt_u32 s97, s90
    s_cselect_b32 s101, s101, 7
    s_lshl_b32 s89, s101, 7
    s_mov_b32 s90, s89
    v_and_b32 v226, 31, v1
    v_lshrrev_b32 v227, 5, v1
    v_bfe_u32 v228, v1, 1, 3
    v_xor_b32 v228, v228, v227
    v_lshlrev_b32 v228, 4, v228
    v_lshl_add_u32 v228, v226, 7, v228
    s_lshl_b32 s96, s95, 12
    v_add_u32 v9, s96, v228
    v_xor_b32 v10, 32, v9
    v_xor_b32 v11, 64, v9
    v_xor_b32 v12, 0x60, v9
    v_bfe_u32 v228, v1, 2, 2
    v_lshl_add_u32 v230, v227, 3, v228
    v_lshlrev_b32 v230, 7, v230
    v_lshrrev_b32 v228, 1, v228
    v_xor_b32 v228, s94, v228
    v_lshl_add_u32 v230, v228, 6, v230
    v_bfe_u32 v227, v1, 4, 1
    v_lshl_add_u32 v230, v227, 5, v230
    v_and_b32 v228, 3, v1
    v_lshl_add_u32 v13, v228, 3, v230
    v_add_u32 v14, 0x10000, v13
    v_add_u32 v15, 0x20000, v13
    v_lshlrev_b32 v2, 4, v1
    v_add_u32 v0, 28672, v2
    v_mov_b32 v241, 0
    s_lshl_b32 s96, s4, 8
    s_lshl_b32 s97, s5, 8
    s_add_u32 s96, s96, 16384
    s_add_u32 s97, s97, 20480
    s_sub_u32 s97, s97, s96
    v_and_b32 v228, 15, v1
    v_mul_lo_u32 v227, v227, s97
    v_lshl_add_u32 v8, v228, 2, v227
    v_add_u32 v8, s96, v8
    buffer_load_dwordx4 v[176:179], v242, s[32:35], s98 offen
    s_add_u32 s98, s98, s99
    buffer_load_dwordx4 v[180:183], v242, s[32:35], s98 offen
    s_add_u32 s98, s98, s99
    buffer_load_dwordx4 v[184:187], v242, s[32:35], s98 offen
    s_add_u32 s98, s98, s99
    buffer_load_dwordx4 v[188:191], v243, s[32:35], s98 offen
    s_waitcnt lgkmcnt(0)
    s_mul_i32 s7, s7, 0x41c64e6d
    s_add_u32 s7, s7, 0x3039
    s_and_b32 s41, s41, 0xffff
    s_mov_b32 s42, 33554432
    s_mov_b32 s43, 0x20000
    s_and_b32 s65, s65, 0xffff
    s_mov_b32 s66, 1605632
    s_mov_b32 s67, 0x20000
    s_and_b32 s69, s69, 0xffff
    s_mov_b32 s70, 401408
    s_mov_b32 s71, 0x20000
    s_waitcnt vmcnt(9)
    s_barrier
    ds_read_b128 v[16:19], v9 offset:0
    ds_read_b64_tr_b16 v[208:209], v14 offset:0
    ds_read_b64_tr_b16 v[210:211], v14 offset:512
    ds_read_b64_tr_b16 v[212:213], v14 offset:8192
    ds_read_b64_tr_b16 v[214:215], v14 offset:8704
    ds_read_b64_tr_b16 v[216:217], v14 offset:16384
    ds_read_b64_tr_b16 v[218:219], v14 offset:16896
    ds_read_b128 v[20:23], v10 offset:0
    ds_read_b128 v[24:27], v11 offset:0
    ds_read_b128 v[28:31], v12 offset:0
    s_waitcnt lgkmcnt(7)
    v_mfma_f32_32x32x16_bf16 v[128:143], v[208:211], v[16:19], 0
    ds_read_b64_tr_b16 v[220:221], v14 offset:2048
    ds_read_b64_tr_b16 v[222:223], v14 offset:2560
    s_waitcnt lgkmcnt(7)
    v_mfma_f32_32x32x16_bf16 v[144:159], v[212:215], v[16:19], 0
    ds_read_b64_tr_b16 v[208:209], v14 offset:10240
    ds_read_b64_tr_b16 v[210:211], v14 offset:10752
    s_add_u32 m0, s6, 32768
    s_add_u32 s14, s14, 128
    buffer_load_dwordx4 v7, s[36:39], s14 offen lds
    s_waitcnt lgkmcnt(7)
    v_mfma_f32_32x32x16_bf16 v[160:175], v[216:219], v[16:19], 0
    ds_read_b64_tr_b16 v[212:213], v14 offset:18432
    ds_read_b64_tr_b16 v[214:215], v14 offset:18944
    s_add_u32 m0, s6, 40960
    s_add_u32 s15, s15, 128
    buffer_load_dwordx4 v7, s[36:39], s15 offen lds
    s_waitcnt lgkmcnt(4)
    v_mfma_f32_32x32x16_bf16 v[128:143], v[220:223], v[20:23], v[128:143]
    ds_read_b64_tr_b16 v[216:217], v14 offset:4096
    ds_read_b64_tr_b16 v[218:219], v14 offset:4608
    s_waitcnt lgkmcnt(4)
    v_mfma_f32_32x32x16_bf16 v[144:159], v[208:211], v[20:23], v[144:159]
    ds_read_b64_tr_b16 v[220:221], v14 offset:12288
    ds_read_b64_tr_b16 v[222:223], v14 offset:12800
    s_add_u32 m0, s6, 114688
    s_add_u32 s8, s8, 172032
    buffer_load_dwordx4 v3, s[44:47], s8 offen lds
    s_waitcnt lgkmcnt(4)
    v_mfma_f32_32x32x16_bf16 v[160:175], v[212:215], v[20:23], v[160:175]
    ds_read_b64_tr_b16 v[208:209], v14 offset:20480
    ds_read_b64_tr_b16 v[210:211], v14 offset:20992
    s_add_u32 m0, s6, 122880
    s_add_u32 s9, s9, s13
    buffer_load_dwordx4 v5, s[48:51], s9 offen lds
    s_waitcnt lgkmcnt(4)
    v_mfma_f32_32x32x16_bf16 v[128:143], v[216:219], v[24:27], v[128:143]
    ds_read_b64_tr_b16 v[212:213], v14 offset:6144
    ds_read_b64_tr_b16 v[214:215], v14 offset:6656
    s_waitcnt lgkmcnt(4)
    v_mfma_f32_32x32x16_bf16 v[144:159], v[220:223], v[24:27], v[144:159]
    ds_read_b64_tr_b16 v[216:217], v14 offset:14336
    ds_read_b64_tr_b16 v[218:219], v14 offset:14848
    s_add_u32 m0, s6, 131072
    s_add_u32 s10, s10, s13
    buffer_load_dwordx4 v5, s[52:55], s10 offen lds
    s_waitcnt lgkmcnt(4)
    v_mfma_f32_32x32x16_bf16 v[160:175], v[208:211], v[24:27], v[160:175]
    ds_read_b64_tr_b16 v[220:221], v14 offset:22528
    ds_read_b64_tr_b16 v[222:223], v14 offset:23040
    s_waitcnt lgkmcnt(4)
    v_mfma_f32_32x32x16_bf16 v[128:143], v[212:215], v[28:31], v[128:143]
    s_waitcnt vmcnt(9)
    s_barrier
    ds_read_b64_tr_b16 v[208:209], v14 offset:24576
    ds_read_b64_tr_b16 v[210:211], v14 offset:25088
    ds_read_b128 v[32:35], v9 offset:16384
    s_waitcnt vmcnt(5)
    s_cmp_ge_u32 s3, 4
    s_cbranch_scc1 L_ecol_2
    s_movk_i32 s94, 0x3f80
    s_mov_b32 s95, 0x3f800000
    s_lshl_b32 s98, s5, 14
    s_lshl_b32 s96, s3, 11
    s_add_u32 s98, s98, s96
    s_lshl_b32 s96, s4, 7
    s_add_u32 s98, s98, s96
    s_add_u32 s98, s98, 131072
    s_bfe_u32 s96, s4, 0x10001
    s_lshl_b32 s96, s96, 6
    v_lshrrev_b32 v240, 4, v1
    v_and_b32 v241, 0x70, v2
    v_lshl_add_u32 v241, v240, 2, v241
    v_xor_b32 v241, s96, v241
    v_mov_b32 v232, 0
    v_mov_b32 v233, 0
    v_mov_b32 v234, 0
    v_mov_b32 v235, 0
    v_mov_b32 v236, 0
    v_mov_b32 v237, 0
    v_mov_b32 v238, 0
    v_mov_b32 v239, 0
    v_dot2c_f32_bf16 v232, s94, v176
    v_dot2c_f32_bf16 v233, s95, v176
    v_dot2c_f32_bf16 v234, s94, v177
    v_dot2c_f32_bf16 v235, s95, v177
    v_dot2c_f32_bf16 v236, s94, v178
    v_dot2c_f32_bf16 v237, s95, v178
    v_dot2c_f32_bf16 v238, s94, v179
    v_dot2c_f32_bf16 v239, s95, v179
    v_dot2c_f32_bf16 v232, s94, v180
    v_dot2c_f32_bf16 v233, s95, v180
    v_dot2c_f32_bf16 v234, s94, v181
    v_dot2c_f32_bf16 v235, s95, v181
    v_dot2c_f32_bf16 v236, s94, v182
    v_dot2c_f32_bf16 v237, s95, v182
    v_dot2c_f32_bf16 v238, s94, v183
    v_dot2c_f32_bf16 v239, s95, v183
    v_dot2c_f32_bf16 v232, s94, v184
    v_dot2c_f32_bf16 v233, s95, v184
    v_dot2c_f32_bf16 v234, s94, v185
    v_dot2c_f32_bf16 v235, s95, v185
    v_dot2c_f32_bf16 v236, s94, v186
    v_dot2c_f32_bf16 v237, s95, v186
    v_dot2c_f32_bf16 v238, s94, v187
    v_dot2c_f32_bf16 v239, s95, v187
    v_dot2c_f32_bf16 v232, s94, v188
    v_dot2c_f32_bf16 v233, s95, v188
    v_dot2c_f32_bf16 v234, s94, v189
    v_dot2c_f32_bf16 v235, s95, v189
    v_dot2c_f32_bf16 v236, s94, v190
    v_dot2c_f32_bf16 v237, s95, v190
    v_dot2c_f32_bf16 v238, s94, v191
    v_dot2c_f32_bf16 v239, s95, v191
    v_permlane32_swap_b32 v232, v236
    v_permlane32_swap_b32 v233, v237
    v_permlane32_swap_b32 v234, v238
    v_permlane32_swap_b32 v235, v239
    v_add_f32 v232, v232, v236
    v_add_f32 v233, v233, v237
    v_add_f32 v234, v234, v238
    v_add_f32 v235, v235, v239
    s_nop 0
    v_permlane16_swap_b32 v232, v234
    v_permlane16_swap_b32 v233, v235
    v_add_f32 v232, v232, v234
    v_add_f32 v233, v233, v235
    s_nop 0
    v_add_f32_dpp v232, v232, v232 row_ror:8 row_mask:0xf bank_mask:0xf
    v_add_f32_dpp v233, v233, v233 row_ror:8 row_mask:0xf bank_mask:0xf
    v_cvt_pk_bf16_f32 v240, v232, v233
L_ecol_2:
    s_waitcnt lgkmcnt(5)
    v_mfma_f32_32x32x16_bf16 v[144:159], v[216:219], v[28:31], v[144:159]
    ds_read_b64_tr_b16 v[212:213], v14 offset:32768
    ds_read_b64_tr_b16 v[214:215], v14 offset:33280
    ds_read_b128 v[36:39], v10 offset:16384
    s_add_u32 m0, s6, 49152
    s_add_u32 s14, s14, 128
    buffer_load_dwordx4 v7, s[36:39], s14 offen lds
    s_waitcnt lgkmcnt(6)
    v_mfma_f32_32x32x16_bf16 v[160:175], v[220:223], v[28:31], v[160:175]
    ds_read_b64_tr_b16 v[216:217], v14 offset:40960
    ds_read_b64_tr_b16 v[218:219], v14 offset:41472
    s_waitcnt lgkmcnt(5)
    v_mfma_f32_32x32x16_bf16 v[128:143], v[208:211], v[32:35], v[128:143]
    ds_read_b64_tr_b16 v[220:221], v14 offset:26624
    ds_read_b64_tr_b16 v[222:223], v14 offset:27136
    ds_read_b128 v[40:43], v11 offset:16384
    s_add_u32 m0, s6, 57344
    s_add_u32 s15, s15, 128
    buffer_load_dwordx4 v7, s[36:39], s15 offen lds
    s_waitcnt lgkmcnt(6)
    v_mfma_f32_32x32x16_bf16 v[144:159], v[212:215], v[32:35], v[144:159]
    ds_read_b64_tr_b16 v[208:209], v14 offset:34816
    ds_read_b64_tr_b16 v[210:211], v14 offset:35328
    s_waitcnt lgkmcnt(5)
    v_mfma_f32_32x32x16_bf16 v[160:175], v[216:219], v[32:35], v[160:175]
    ds_read_b64_tr_b16 v[212:213], v14 offset:43008
    ds_read_b64_tr_b16 v[214:215], v14 offset:43520
    ds_read_b128 v[44:47], v12 offset:16384
    s_add_u32 m0, s6, 139264
    s_add_u32 s8, s8, 172032
    buffer_load_dwordx4 v3, s[44:47], s8 offen lds
    s_waitcnt lgkmcnt(6)
    v_mfma_f32_32x32x16_bf16 v[128:143], v[220:223], v[36:39], v[128:143]
    ds_read_b64_tr_b16 v[216:217], v14 offset:28672
    ds_read_b64_tr_b16 v[218:219], v14 offset:29184
    s_waitcnt lgkmcnt(5)
    v_mfma_f32_32x32x16_bf16 v[144:159], v[208:211], v[36:39], v[144:159]
    ds_read_b64_tr_b16 v[220:221], v14 offset:36864
    ds_read_b64_tr_b16 v[222:223], v14 offset:37376
    s_add_u32 m0, s6, 147456
    s_add_u32 s9, s9, s13
    buffer_load_dwordx4 v5, s[48:51], s9 offen lds
    s_waitcnt lgkmcnt(5)
    v_mfma_f32_32x32x16_bf16 v[160:175], v[212:215], v[36:39], v[160:175]
    ds_read_b64_tr_b16 v[208:209], v14 offset:45056
    ds_read_b64_tr_b16 v[210:211], v14 offset:45568
    s_waitcnt lgkmcnt(4)
    v_mfma_f32_32x32x16_bf16 v[128:143], v[216:219], v[40:43], v[128:143]
    ds_read_b64_tr_b16 v[212:213], v14 offset:30720
    ds_read_b64_tr_b16 v[214:215], v14 offset:31232
    s_add_u32 m0, s6, 155648
    s_add_u32 s10, s10, s13
    buffer_load_dwordx4 v5, s[52:55], s10 offen lds
    s_waitcnt lgkmcnt(4)
    v_mfma_f32_32x32x16_bf16 v[144:159], v[220:223], v[40:43], v[144:159]
    ds_read_b64_tr_b16 v[216:217], v14 offset:38912
    ds_read_b64_tr_b16 v[218:219], v14 offset:39424
    s_cmp_lg_u32 s3, 4
    s_cbranch_scc1 L_ecol_3
    s_movk_i32 s94, 0x3f80
    s_mov_b32 s95, 0x3f800000
    s_lshl_b32 s98, s5, 14
    s_lshl_b32 s96, s3, 11
    s_add_u32 s98, s98, s96
    s_lshl_b32 s96, s4, 7
    s_add_u32 s98, s98, s96
    s_add_u32 s98, s98, 131072
    s_bfe_u32 s96, s4, 0x10001
    s_lshl_b32 s96, s96, 6
    v_lshrrev_b32 v240, 4, v1
    v_and_b32 v241, 0x70, v2
    v_lshl_add_u32 v241, v240, 2, v241
    v_xor_b32 v241, s96, v241
    v_mov_b32 v232, 0
    v_mov_b32 v233, 0
    v_mov_b32 v234, 0
    v_mov_b32 v235, 0
    v_mov_b32 v236, 0
    v_mov_b32 v237, 0
    v_mov_b32 v238, 0
    v_mov_b32 v239, 0
    v_dot2c_f32_bf16 v232, s94, v176
    v_dot2c_f32_bf16 v233, s95, v176
    v_dot2c_f32_bf16 v234, s94, v177
    v_dot2c_f32_bf16 v235, s95, v177
    v_dot2c_f32_bf16 v236, s94, v178
    v_dot2c_f32_bf16 v237, s95, v178
    v_dot2c_f32_bf16 v238, s94, v179
    v_dot2c_f32_bf16 v239, s95, v179
    v_dot2c_f32_bf16 v232, s94, v180
    v_dot2c_f32_bf16 v233, s95, v180
    v_dot2c_f32_bf16 v234, s94, v181
    v_dot2c_f32_bf16 v235, s95, v181
    v_dot2c_f32_bf16 v236, s94, v182
    v_dot2c_f32_bf16 v237, s95, v182
    v_dot2c_f32_bf16 v238, s94, v183
    v_dot2c_f32_bf16 v239, s95, v183
    v_dot2c_f32_bf16 v232, s94, v184
    v_dot2c_f32_bf16 v233, s95, v184
    v_dot2c_f32_bf16 v234, s94, v185
    v_dot2c_f32_bf16 v235, s95, v185
    v_dot2c_f32_bf16 v236, s94, v186
    v_dot2c_f32_bf16 v237, s95, v186
    v_dot2c_f32_bf16 v238, s94, v187
    v_dot2c_f32_bf16 v239, s95, v187
    v_dot2c_f32_bf16 v232, s94, v188
    v_dot2c_f32_bf16 v233, s95, v188
    v_dot2c_f32_bf16 v234, s94, v189
    v_dot2c_f32_bf16 v235, s95, v189
    v_dot2c_f32_bf16 v236, s94, v190
    v_dot2c_f32_bf16 v237, s95, v190
    v_dot2c_f32_bf16 v238, s94, v191
    v_dot2c_f32_bf16 v239, s95, v191
    v_permlane32_swap_b32 v232, v236
    v_permlane32_swap_b32 v233, v237
    v_permlane32_swap_b32 v234, v238
    v_permlane32_swap_b32 v235, v239
    v_add_f32 v232, v232, v236
    v_add_f32 v233, v233, v237
    v_add_f32 v234, v234, v238
    v_add_f32 v235, v235, v239
    s_nop 0
    v_permlane16_swap_b32 v232, v234
    v_permlane16_swap_b32 v233, v235
    v_add_f32 v232, v232, v234
    v_add_f32 v233, v233, v235
    s_nop 0
    v_add_f32_dpp v232, v232, v232 row_ror:8 row_mask:0xf bank_mask:0xf
    v_add_f32_dpp v233, v233, v233 row_ror:8 row_mask:0xf bank_mask:0xf
    v_cvt_pk_bf16_f32 v240, v232, v233
L_ecol_3:
    s_cmp_lt_u32 s3, 5
    s_cbranch_scc1 L_erow_4
    s_cmp_eq_u32 s3, 7
    s_cbranch_scc1 L_ew7_5
    s_mov_b32 s94, 0x3f803f80
    s_lshl_b32 s98, s4, 4
    s_add_u32 s98, s98, s5
    s_lshl_b32 s98, s98, 1
    s_add_u32 s98, s98, s3
    s_lshl_b32 s98, s98, 6
    s_add_u32 s98, s98, 65216
    v_and_b32 v240, 3, v1
    v_and_b32 v241, 0x30, v1
    v_lshl_add_u32 v241, v240, 2, v241
    v_mov_b32 v232, 0
    v_mov_b32 v233, 0
    v_mov_b32 v234, 0
    v_mov_b32 v235, 0
    v_dot2c_f32_bf16 v232, s94, v176
    v_dot2c_f32_bf16 v233, v176, v176
    v_dot2c_f32_bf16 v234, s94, v177
    v_dot2c_f32_bf16 v235, v177, v177
    v_dot2c_f32_bf16 v232, s94, v178
    v_dot2c_f32_bf16 v233, v178, v178
    v_dot2c_f32_bf16 v234, s94, v179
    v_dot2c_f32_bf16 v235, v179, v179
    v_dot2c_f32_bf16 v232, s94, v180
    v_dot2c_f32_bf16 v233, v180, v180
    v_dot2c_f32_bf16 v234, s94, v181
    v_dot2c_f32_bf16 v235, v181, v181
    v_dot2c_f32_bf16 v232, s94, v182
    v_dot2c_f32_bf16 v233, v182, v182
    v_dot2c_f32_bf16 v234, s94, v183
    v_dot2c_f32_bf16 v235, v183, v183
    v_dot2c_f32_bf16 v232, s94, v184
    v_dot2c_f32_bf16 v233, v184, v184
    v_dot2c_f32_bf16 v234, s94, v185
    v_dot2c_f32_bf16 v235, v185, v185
    v_dot2c_f32_bf16 v232, s94, v186
    v_dot2c_f32_bf16 v233, v186, v186
    v_dot2c_f32_bf16 v234, s94, v187
    v_dot2c_f32_bf16 v235, v187, v187
    v_dot2c_f32_bf16 v232, s94, v188
    v_dot2c_f32_bf16 v233, v188, v188
    v_dot2c_f32_bf16 v234, s94, v189
    v_dot2c_f32_bf16 v235, v189, v189
    v_dot2c_f32_bf16 v232, s94, v190
    v_dot2c_f32_bf16 v233, v190, v190
    v_dot2c_f32_bf16 v234, s94, v191
    v_dot2c_f32_bf16 v235, v191, v191
    s_nop 1
    v_add_f32 v232, v232, v234
    v_add_f32 v233, v233, v235
    s_nop 0
    v_add_f32_dpp v232, v232, v232 quad_perm:[1,0,3,2] row_mask:0xf bank_mask:0xf
    v_add_f32_dpp v233, v233, v233 quad_perm:[1,0,3,2] row_mask:0xf bank_mask:0xf
    s_nop 0
    v_add_f32_dpp v232, v232, v232 quad_perm:[2,3,0,1] row_mask:0xf bank_mask:0xf
    v_add_f32_dpp v233, v233, v233 quad_perm:[2,3,0,1] row_mask:0xf bank_mask:0xf
    s_nop 0
    v_add_f32_dpp v232, v232, v232 row_half_mirror row_mask:0xf bank_mask:0xf
    v_add_f32_dpp v233, v233, v233 row_half_mirror row_mask:0xf bank_mask:0xf
    s_nop 0
    v_add_f32_dpp v232, v232, v232 row_mirror row_mask:0xf bank_mask:0xf
    v_add_f32_dpp v233, v233, v233 row_mirror row_mask:0xf bank_mask:0xf
    v_mul_f32 v232, 991054117, v232
    v_mul_f32 v233, 991054117, v233
    v_fma_f32 v233, -v232, v232, v233
    v_max_f32 v233, 0, v233
    v_add_f32 v233, 0x3727c5ac, v233
    v_rsq_f32 v234, v233
    v_cvt_pk_bf16_f32 v232, -v232, -v232
    v_cmp_eq_u32 vcc, 2, v240
    v_mul_f32 v235, 0xbfb8aa3b, v234
    s_nop 0
    v_cndmask_b32 v233, v233, v235, vcc
    v_cmp_eq_u32 vcc, 1, v240
    s_nop 1
    v_cndmask_b32 v233, v233, v234, vcc
    v_cmp_eq_u32 vcc, 0, v240
    s_nop 1
    v_cndmask_b32 v240, v233, v232, vcc
    s_branch L_erow_4
L_ew7_5:
    s_mov_b32 s98, 33554432
    v_mov_b32 v241, 0
    s_or_b32 s94, s4, s5
    s_cmp_lg_u32 s94, 0
    s_cbranch_scc1 L_erow_4
    s_mov_b32 s95, 458752
    v_cmp_gt_u32 vcc, 32, v1
    v_mov_b32 v236, 0xf149
    v_mov_b32 v232, 0
    v_mov_b32 v233, 0
    v_mov_b32 v234, 0
    v_mov_b32 v235, 0
    v_mov_b32 v237, 0
    v_mov_b32 v238, 0
    v_mov_b32 v239, 0
    buffer_store_dwordx4 v[232:235], v2, s[40:43], s95 offen offset:0 sc1
    buffer_store_dwordx4 v[232:235], v2, s[40:43], s95 offen offset:3072 sc1
    s_nop 1
    v_cndmask_b32 v234, v236, 0, vcc
    v_cndmask_b32 v236, 0, v236, vcc
    buffer_store_dwordx4 v[232:235], v2, s[40:43], s95 offen offset:1024 sc1
    buffer_store_dwordx4 v[236:239], v2, s[40:43], s95 offen offset:2048 sc1
L_erow_4:
    s_nop 1
    buffer_store_dword v240, v241, s[40:43], s98 offen sc1
    s_waitcnt lgkmcnt(4)
    v_mfma_f32_32x32x16_bf16 v[160:175], v[208:211], v[40:43], v[160:175]
    ds_read_b64_tr_b16 v[220:221], v14 offset:47104
    ds_read_b64_tr_b16 v[222:223], v14 offset:47616
    s_waitcnt lgkmcnt(4)
    v_mfma_f32_32x32x16_bf16 v[128:143], v[212:215], v[44:47], v[128:143]
    s_waitcnt vmcnt(6)
    s_barrier
    ds_read_b64_tr_b16 v[208:209], v14 offset:49152
    ds_read_b64_tr_b16 v[210:211], v14 offset:49664
    ds_read_b128 v[48:51], v9 offset:32768
    s_waitcnt vmcnt(0)
    s_barrier
    s_cmp_lg_u32 s3, 0
    s_cbranch_scc1 L_sigp_6
    s_lshl_b32 s96, s5, 8
    s_lshl_b32 s97, s4, 2
    s_add_u32 s96, s96, s97
    s_add_u32 s96, s96, 20480
    s_add_u32 s97, s83, 16384
    v_mov_b32 v224, s7
    v_mov_b32 v225, s96
    v_writelane_b32 v225, s97, 0
    s_mov_b64 exec, 3
    buffer_store_dword v224, v225, s[40:43], 0 offen sc1
    s_mov_b64 exec, -1
L_sigp_6:
    s_waitcnt lgkmcnt(5)
    v_mfma_f32_32x32x16_bf16 v[144:159], v[216:219], v[44:47], v[144:159]
    ds_read_b64_tr_b16 v[212:213], v14 offset:57344
    ds_read_b64_tr_b16 v[214:215], v14 offset:57856
    ds_read_b128 v[52:55], v10 offset:32768
    s_add_u32 m0, s6, 0
    s_add_u32 s14, s14, 128
    buffer_load_dwordx4 v7, s[36:39], s14 offen lds
    s_waitcnt lgkmcnt(6)
    v_mfma_f32_32x32x16_bf16 v[160:175], v[220:223], v[44:47], v[160:175]
    ds_read_b64_tr_b16 v[216:217], v15 offset:0
    ds_read_b64_tr_b16 v[218:219], v15 offset:512
    s_waitcnt lgkmcnt(5)
    v_mfma_f32_32x32x16_bf16 v[128:143], v[208:211], v[48:51], v[128:143]
    ds_read_b64_tr_b16 v[220:221], v14 offset:51200
    ds_read_b64_tr_b16 v[222:223], v14 offset:51712
    ds_read_b128 v[56:59], v11 offset:32768
    s_add_u32 m0, s6, 8192
    s_add_u32 s15, s15, 128
    buffer_load_dwordx4 v7, s[36:39], s15 offen lds
    s_waitcnt lgkmcnt(6)
    v_mfma_f32_32x32x16_bf16 v[144:159], v[212:215], v[48:51], v[144:159]
    ds_read_b64_tr_b16 v[208:209], v14 offset:59392
    ds_read_b64_tr_b16 v[210:211], v14 offset:59904
    s_waitcnt lgkmcnt(5)
    v_mfma_f32_32x32x16_bf16 v[160:175], v[216:219], v[48:51], v[160:175]
    ds_read_b64_tr_b16 v[212:213], v15 offset:2048
    ds_read_b64_tr_b16 v[214:215], v15 offset:2560
    ds_read_b128 v[60:63], v12 offset:32768
    s_add_u32 m0, s6, 65536
    s_add_u32 s8, s8, 172032
    buffer_load_dwordx4 v3, s[44:47], s8 offen lds
    s_waitcnt lgkmcnt(6)
    v_mfma_f32_32x32x16_bf16 v[128:143], v[220:223], v[52:55], v[128:143]
    ds_read_b64_tr_b16 v[216:217], v14 offset:53248
    ds_read_b64_tr_b16 v[218:219], v14 offset:53760
    s_waitcnt lgkmcnt(5)
    v_mfma_f32_32x32x16_bf16 v[144:159], v[208:211], v[52:55], v[144:159]
    ds_read_b64_tr_b16 v[220:221], v14 offset:61440
    ds_read_b64_tr_b16 v[222:223], v14 offset:61952
    s_add_u32 m0, s6, 73728
    s_add_u32 s9, s9, s13
    buffer_load_dwordx4 v5, s[48:51], s9 offen lds
    s_waitcnt lgkmcnt(5)
    v_mfma_f32_32x32x16_bf16 v[160:175], v[212:215], v[52:55], v[160:175]
    ds_read_b64_tr_b16 v[208:209], v15 offset:4096
    ds_read_b64_tr_b16 v[210:211], v15 offset:4608
    s_waitcnt lgkmcnt(4)
    v_mfma_f32_32x32x16_bf16 v[128:143], v[216:219], v[56:59], v[128:143]
    ds_read_b64_tr_b16 v[212:213], v14 offset:55296
    ds_read_b64_tr_b16 v[214:215], v14 offset:55808
    s_add_u32 m0, s6, 81920
    s_add_u32 s10, s10, s13
    buffer_load_dwordx4 v5, s[52:55], s10 offen lds
    s_waitcnt lgkmcnt(4)
    v_mfma_f32_32x32x16_bf16 v[144:159], v[220:223], v[56:59], v[144:159]
    ds_read_b64_tr_b16 v[216:217], v14 offset:63488
    ds_read_b64_tr_b16 v[218:219], v14 offset:64000
    s_waitcnt lgkmcnt(4)
    v_mfma_f32_32x32x16_bf16 v[160:175], v[208:211], v[56:59], v[160:175]
    ds_read_b64_tr_b16 v[220:221], v15 offset:6144
    ds_read_b64_tr_b16 v[222:223], v15 offset:6656
    s_waitcnt lgkmcnt(4)
    v_mfma_f32_32x32x16_bf16 v[128:143], v[212:215], v[60:63], v[128:143]
    s_barrier
    ds_read_b64_tr_b16 v[208:209], v15 offset:8192
    ds_read_b64_tr_b16 v[210:211], v15 offset:8704
    ds_read_b128 v[64:67], v9 offset:49152
    s_waitcnt lgkmcnt(5)
    v_mfma_f32_32x32x16_bf16 v[144:159], v[216:219], v[60:63], v[144:159]
    ds_read_b64_tr_b16 v[212:213], v15 offset:16384
    ds_read_b64_tr_b16 v[214:215], v15 offset:16896
    ds_read_b128 v[68:71], v10 offset:49152
    s_add_u32 m0, s6, 16384
    s_add_u32 s14, s14, 128
    buffer_load_dwordx4 v7, s[36:39], s14 offen lds
    s_waitcnt lgkmcnt(6)
    v_mfma_f32_32x32x16_bf16 v[160:175], v[220:223], v[60:63], v[160:175]
    ds_read_b64_tr_b16 v[216:217], v15 offset:24576
    ds_read_b64_tr_b16 v[218:219], v15 offset:25088
    s_add_u32 m0, s6, 24576
    s_add_u32 s15, s15, 128
    buffer_load_dwordx4 v7, s[36:39], s15 offen lds
    s_waitcnt lgkmcnt(5)
    v_mfma_f32_32x32x16_bf16 v[128:143], v[208:211], v[64:67], v[128:143]
    ds_read_b64_tr_b16 v[220:221], v15 offset:10240
    ds_read_b64_tr_b16 v[222:223], v15 offset:10752
    ds_read_b128 v[72:75], v11 offset:49152
    s_waitcnt lgkmcnt(6)
    v_mfma_f32_32x32x16_bf16 v[144:159], v[212:215], v[64:67], v[144:159]
    ds_read_b64_tr_b16 v[208:209], v15 offset:18432
    ds_read_b64_tr_b16 v[210:211], v15 offset:18944
    s_add_u32 m0, s6, 90112
    s_add_u32 s8, s8, 172032
    buffer_load_dwordx4 v3, s[44:47], s8 offen lds
    s_waitcnt lgkmcnt(5)
    v_mfma_f32_32x32x16_bf16 v[160:175], v[216:219], v[64:67], v[160:175]
    ds_read_b64_tr_b16 v[212:213], v15 offset:26624
    ds_read_b64_tr_b16 v[214:215], v15 offset:27136
    ds_read_b128 v[76:79], v12 offset:49152
    s_waitcnt lgkmcnt(6)
    v_mfma_f32_32x32x16_bf16 v[128:143], v[220:223], v[68:71], v[128:143]
    ds_read_b64_tr_b16 v[216:217], v15 offset:12288
    ds_read_b64_tr_b16 v[218:219], v15 offset:12800
    s_add_u32 m0, s6, 98304
    s_add_u32 s9, s9, s13
    buffer_load_dwordx4 v5, s[48:51], s9 offen lds
    s_waitcnt lgkmcnt(5)
    v_mfma_f32_32x32x16_bf16 v[144:159], v[208:211], v[68:71], v[144:159]
    ds_read_b64_tr_b16 v[220:221], v15 offset:20480
    ds_read_b64_tr_b16 v[222:223], v15 offset:20992
    s_waitcnt lgkmcnt(5)
    v_mfma_f32_32x32x16_bf16 v[160:175], v[212:215], v[68:71], v[160:175]
    ds_read_b64_tr_b16 v[208:209], v15 offset:28672
    ds_read_b64_tr_b16 v[210:211], v15 offset:29184
    s_add_u32 m0, s6, 106496
    s_add_u32 s10, s10, s13
    buffer_load_dwordx4 v5, s[52:55], s10 offen lds
    s_waitcnt lgkmcnt(4)
    v_mfma_f32_32x32x16_bf16 v[128:143], v[216:219], v[72:75], v[128:143]
    ds_read_b64_tr_b16 v[212:213], v15 offset:14336
    ds_read_b64_tr_b16 v[214:215], v15 offset:14848
    s_waitcnt lgkmcnt(4)
    v_mfma_f32_32x32x16_bf16 v[144:159], v[220:223], v[72:75], v[144:159]
    ds_read_b64_tr_b16 v[216:217], v15 offset:22528
    ds_read_b64_tr_b16 v[218:219], v15 offset:23040
    s_cmp_lt_u32 s3, 6
    s_cselect_b64 s[72:73], s[64:65], s[68:69]
    s_cselect_b32 s74, 1605632, s70
    s_mov_b32 s75, 0x20000
    s_cselect_b32 s98, 9, 7
    s_cselect_b32 s99, 6, 2
    s_cselect_b32 s100, 0, 6
    s_sub_u32 s100, s3, s100
    s_lshr_b32 vcc_lo, s2, 0
    s_mul_i32 vcc_lo, vcc_lo, s99
    s_add_u32 s100, s100, vcc_lo
    s_mul_i32 s100, s100, s98
    s_cmp_lt_u32 s3, 6
    s_cselect_b32 vcc_lo, 0, 0
    s_add_u32 vcc_lo, s100, vcc_lo
    s_mul_i32 s100, s98, s99
    s_lshl_b32 s100, s100, 15
    v_add_u32 v246, vcc_lo, v1
    v_cmp_gt_u32 vcc, s98, v1
    v_lshlrev_b32 v246, 7, v246
    v_mov_b32 v247, 0x7ff00000
    v_cndmask_b32 v246, v247, v246, vcc
    buffer_load_dword v247, v246, s[72:75], 0 offen
    s_waitcnt lgkmcnt(4)
    v_mfma_f32_32x32x16_bf16 v[160:175], v[208:211], v[72:75], v[160:175]
    ds_read_b64_tr_b16 v[220:221], v15 offset:30720
    ds_read_b64_tr_b16 v[222:223], v15 offset:31232
    s_waitcnt lgkmcnt(4)
    v_mfma_f32_32x32x16_bf16 v[128:143], v[212:215], v[76:79], v[128:143]
    s_waitcnt vmcnt(6)
    s_barrier
    ds_read_b64_tr_b16 v[208:209], v14 offset:0
    ds_read_b64_tr_b16 v[210:211], v14 offset:512
    ds_read_b128 v[80:83], v9 offset:0
    buffer_load_dword v226, v8, s[40:43], 0 offen sc1
    s_waitcnt lgkmcnt(5)
    v_mfma_f32_32x32x16_bf16 v[144:159], v[216:219], v[76:79], v[144:159]
    ds_read_b64_tr_b16 v[212:213], v14 offset:8192
    ds_read_b64_tr_b16 v[214:215], v14 offset:8704
    ds_read_b128 v[84:87], v10 offset:0
    s_add_u32 m0, s6, 32768
    s_add_u32 s14, s14, 128
    buffer_load_dwordx4 v7, s[36:39], s14 offen lds
    s_waitcnt lgkmcnt(6)
    v_mfma_f32_32x32x16_bf16 v[160:175], v[220:223], v[76:79], v[160:175]
    ds_read_b64_tr_b16 v[216:217], v14 offset:16384
    ds_read_b64_tr_b16 v[218:219], v14 offset:16896
    s_waitcnt lgkmcnt(5)
    v_mfma_f32_32x32x16_bf16 v[128:143], v[208:211], v[80:83], v[128:143]
    ds_read_b64_tr_b16 v[220:221], v14 offset:2048
    ds_read_b64_tr_b16 v[222:223], v14 offset:2560
    ds_read_b128 v[88:91], v11 offset:0
    s_add_u32 m0, s6, 40960
    s_add_u32 s15, s15, 128
    buffer_load_dwordx4 v7, s[36:39], s15 offen lds
    s_waitcnt lgkmcnt(6)
    v_mfma_f32_32x32x16_bf16 v[144:159], v[212:215], v[80:83], v[144:159]
    ds_read_b64_tr_b16 v[208:209], v14 offset:10240
    ds_read_b64_tr_b16 v[210:211], v14 offset:10752
    s_waitcnt lgkmcnt(5)
    v_mfma_f32_32x32x16_bf16 v[160:175], v[216:219], v[80:83], v[160:175]
    ds_read_b64_tr_b16 v[212:213], v14 offset:18432
    ds_read_b64_tr_b16 v[214:215], v14 offset:18944
    ds_read_b128 v[92:95], v12 offset:0
    s_add_u32 m0, s6, 114688
    s_add_u32 s8, s8, 172032
    buffer_load_dwordx4 v3, s[44:47], s8 offen lds
    s_waitcnt lgkmcnt(6)
    v_mfma_f32_32x32x16_bf16 v[128:143], v[220:223], v[84:87], v[128:143]
    ds_read_b64_tr_b16 v[216:217], v14 offset:4096
    ds_read_b64_tr_b16 v[218:219], v14 offset:4608
    s_waitcnt lgkmcnt(5)
    v_mfma_f32_32x32x16_bf16 v[144:159], v[208:211], v[84:87], v[144:159]
    ds_read_b64_tr_b16 v[220:221], v14 offset:12288
    ds_read_b64_tr_b16 v[222:223], v14 offset:12800
    s_add_u32 m0, s6, 122880
    s_add_u32 s9, s9, s13
    buffer_load_dwordx4 v5, s[48:51], s9 offen lds
    s_waitcnt lgkmcnt(5)
    v_mfma_f32_32x32x16_bf16 v[160:175], v[212:215], v[84:87], v[160:175]
    ds_read_b64_tr_b16 v[208:209], v14 offset:20480
    ds_read_b64_tr_b16 v[210:211], v14 offset:20992
    s_waitcnt lgkmcnt(4)
    v_mfma_f32_32x32x16_bf16 v[128:143], v[216:219], v[88:91], v[128:143]
    ds_read_b64_tr_b16 v[212:213], v14 offset:6144
    ds_read_b64_tr_b16 v[214:215], v14 offset:6656
    s_add_u32 m0, s6, 131072
    s_add_u32 s10, s10, s13
    buffer_load_dwordx4 v5, s[52:55], s10 offen lds
    s_waitcnt lgkmcnt(4)
    v_mfma_f32_32x32x16_bf16 v[144:159], v[220:223], v[88:91], v[144:159]
    ds_read_b64_tr_b16 v[216:217], v14 offset:14336
    ds_read_b64_tr_b16 v[218:219], v14 offset:14848
    s_waitcnt lgkmcnt(4)
    v_mfma_f32_32x32x16_bf16 v[160:175], v[208:211], v[88:91], v[160:175]
    ds_read_b64_tr_b16 v[220:221], v14 offset:22528
    ds_read_b64_tr_b16 v[222:223], v14 offset:23040
    s_waitcnt lgkmcnt(4)
    v_mfma_f32_32x32x16_bf16 v[128:143], v[212:215], v[92:95], v[128:143]
    s_waitcnt vmcnt(7)
    s_barrier
    ds_read_b64_tr_b16 v[208:209], v14 offset:24576
    ds_read_b64_tr_b16 v[210:211], v14 offset:25088
    ds_read_b128 v[96:99], v9 offset:16384
    s_waitcnt vmcnt(5)
    v_cmp_ne_u32 vcc, s7, v226
    s_nop 0
    s_cmp_lg_u64 vcc, 0
    s_cbranch_scc1 L_spin_7
L_back_8:
    v_and_b32 v227, 0x1f0, v2
    buffer_load_dwordx4 v[248:251], v227, s[40:43], s88 offen sc1
    s_waitcnt lgkmcnt(5)
    v_mfma_f32_32x32x16_bf16 v[144:159], v[216:219], v[92:95], v[144:159]
    ds_read_b64_tr_b16 v[212:213], v14 offset:32768
    ds_read_b64_tr_b16 v[214:215], v14 offset:33280
    ds_read_b128 v[100:103], v10 offset:16384
    s_add_u32 m0, s6, 49152
    s_nop 0
    buffer_load_dwordx4 v2, s[40:43], s86 offen sc1 lds
    s_waitcnt lgkmcnt(6)
    v_mfma_f32_32x32x16_bf16 v[160:175], v[220:223], v[92:95], v[160:175]
    ds_read_b64_tr_b16 v[216:217], v14 offset:40960
    ds_read_b64_tr_b16 v[218:219], v14 offset:41472
    s_waitcnt lgkmcnt(5)
    v_mfma_f32_32x32x16_bf16 v[128:143], v[208:211], v[96:99], v[128:143]
    ds_read_b64_tr_b16 v[220:221], v14 offset:26624
    ds_read_b64_tr_b16 v[222:223], v14 offset:27136
    ds_read_b128 v[104:107], v11 offset:16384
    s_add_u32 m0, s6, 57344
    s_nop 0
    buffer_load_dwordx4 v2, s[40:43], s87 offen sc1 lds
    s_waitcnt lgkmcnt(6)
    v_mfma_f32_32x32x16_bf16 v[144:159], v[212:215], v[96:99], v[144:159]
    ds_read_b64_tr_b16 v[208:209], v14 offset:34816
    ds_read_b64_tr_b16 v[210:211], v14 offset:35328
    s_waitcnt lgkmcnt(5)
    v_mfma_f32_32x32x16_bf16 v[160:175], v[216:219], v[96:99], v[160:175]
    ds_read_b64_tr_b16 v[212:213], v14 offset:43008
    ds_read_b64_tr_b16 v[214:215], v14 offset:43520
    ds_read_b128 v[108:111], v12 offset:16384
    s_add_u32 m0, s6, 139264
    s_nop 0
    buffer_load_dwordx4 v4, s[56:59], s11 offen lds
    s_waitcnt lgkmcnt(6)
    v_mfma_f32_32x32x16_bf16 v[128:143], v[220:223], v[100:103], v[128:143]
    ds_read_b64_tr_b16 v[216:217], v14 offset:28672
    ds_read_b64_tr_b16 v[218:219], v14 offset:29184
    s_waitcnt lgkmcnt(5)
    v_mfma_f32_32x32x16_bf16 v[144:159], v[208:211], v[100:103], v[144:159]
    ds_read_b64_tr_b16 v[220:221], v14 offset:36864
    ds_read_b64_tr_b16 v[222:223], v14 offset:37376
    s_add_u32 m0, s6, 147456
    s_nop 0
    buffer_load_dwordx4 v4, s[60:63], s12 offen lds
    s_waitcnt lgkmcnt(5)
    v_mfma_f32_32x32x16_bf16 v[160:175], v[212:215], v[100:103], v[160:175]
    ds_read_b64_tr_b16 v[208:209], v14 offset:45056
    ds_read_b64_tr_b16 v[210:211], v14 offset:45568
    s_waitcnt lgkmcnt(4)
    v_mfma_f32_32x32x16_bf16 v[128:143], v[216:219], v[104:107], v[128:143]
    ds_read_b64_tr_b16 v[212:213], v14 offset:30720
    ds_read_b64_tr_b16 v[214:215], v14 offset:31232
    s_add_u32 m0, s6, 155648
    s_add_u32 s11, s11, 0x150000
    buffer_load_dwordx4 v4, s[56:59], s11 offen lds
    s_waitcnt lgkmcnt(4)
    v_mfma_f32_32x32x16_bf16 v[144:159], v[220:223], v[104:107], v[144:159]
    ds_read_b64_tr_b16 v[216:217], v14 offset:38912
    ds_read_b64_tr_b16 v[218:219], v14 offset:39424
    s_waitcnt lgkmcnt(4)
    v_mfma_f32_32x32x16_bf16 v[160:175], v[208:211], v[104:107], v[160:175]
    ds_read_b64_tr_b16 v[220:221], v14 offset:47104
    ds_read_b64_tr_b16 v[222:223], v14 offset:47616
    s_waitcnt lgkmcnt(4)
    v_mfma_f32_32x32x16_bf16 v[128:143], v[212:215], v[108:111], v[128:143]
    s_waitcnt vmcnt(6)
    s_barrier
    ds_read_b64_tr_b16 v[208:209], v14 offset:49152
    ds_read_b64_tr_b16 v[210:211], v14 offset:49664
    ds_read_b128 v[112:115], v9 offset:32768
    s_lshr_b32 s94, s3, 1
    s_and_b32 s95, s3, 1
    s_lshl_b32 s96, s91, 2
    s_add_u32 s96, s96, s94
    s_mul_i32 s47, s96, 98304
    s_waitcnt lgkmcnt(5)
    v_mfma_f32_32x32x16_bf16 v[144:159], v[216:219], v[108:111], v[144:159]
    ds_read_b64_tr_b16 v[212:213], v14 offset:57344
    ds_read_b64_tr_b16 v[214:215], v14 offset:57856
    ds_read_b128 v[116:119], v10 offset:32768
    s_add_u32 m0, s6, 0
    s_add_u32 s12, s12, 0x150000
    buffer_load_dwordx4 v4, s[60:63], s12 offen lds
    s_mul_i32 s51, s96, 32768
    s_lshl_b32 s96, s92, 11
    s_add_u32 s47, s47, s96
    s_add_u32 s47, s47, 1048576
    s_waitcnt lgkmcnt(6)
    v_mfma_f32_32x32x16_bf16 v[160:175], v[220:223], v[108:111], v[160:175]
    ds_read_b64_tr_b16 v[216:217], v15 offset:0
    ds_read_b64_tr_b16 v[218:219], v15 offset:512
    s_add_u32 m0, s6, 8192
    s_add_u32 s11, s11, 0xffee8000
    buffer_load_dwordx4 v4, s[56:59], s11 offen lds
    s_lshl_b32 s96, s95, 10
    s_add_u32 s46, s47, s96
    s_add_u32 s46, s46, 32768
    s_add_u32 s50, s46, 32768
    s_and_b32 s97, s92, 1
    s_waitcnt lgkmcnt(5)
    v_mfma_f32_32x32x16_bf16 v[128:143], v[208:211], v[112:115], v[128:143]
    ds_read_b64_tr_b16 v[220:221], v14 offset:51200
    ds_read_b64_tr_b16 v[222:223], v14 offset:51712
    ds_read_b128 v[120:123], v11 offset:32768
    s_lshl_b32 s94, s97, 11
    s_add_u32 s96, s96, s94
    s_add_u32 s96, s96, 458752
    s_sub_u32 s45, s46, 393216
    s_waitcnt lgkmcnt(6)
    v_mfma_f32_32x32x16_bf16 v[144:159], v[212:215], v[112:115], v[144:159]
    ds_read_b64_tr_b16 v[208:209], v14 offset:59392
    ds_read_b64_tr_b16 v[210:211], v14 offset:59904
    s_add_u32 m0, s6, 65536
    s_add_u32 s12, s12, 0xffee8000
    buffer_load_dwordx4 v4, s[60:63], s12 offen lds
    s_sub_u32 s49, s50, 393216
    s_sub_u32 s44, s46, 786432
    s_sub_u32 s48, s50, 786432
    s_cmp_ge_u32 s91, 1
    s_cselect_b32 s45, s45, s96
    s_cselect_b32 s49, s49, s96
    s_cmp_ge_u32 s91, 2
    s_cselect_b32 s44, s44, s96
    s_cselect_b32 s48, s48, s96
    s_waitcnt lgkmcnt(5)
    v_mfma_f32_32x32x16_bf16 v[160:175], v[216:219], v[112:115], v[160:175]
    ds_read_b64_tr_b16 v[212:213], v15 offset:2048
    ds_read_b64_tr_b16 v[214:215], v15 offset:2560
    ds_read_b128 v[124:127], v12 offset:32768
    s_add_u32 m0, s6, 73728
    s_add_u32 s11, s11, 0x38000
    buffer_load_dwordx4 v4, s[56:59], s11 offen lds
    s_lshl_b32 s96, s95, 8
    s_add_u32 s47, s47, s96
    s_add_u32 s51, s51, s96
    s_lshr_b32 s96, s92, 2
    s_mul_i32 s96, s96, 7168
    s_add_u32 s51, s51, s96
    s_waitcnt lgkmcnt(6)
    v_mfma_f32_32x32x16_bf16 v[128:143], v[220:223], v[116:119], v[128:143]
    ds_read_b64_tr_b16 v[216:217], v14 offset:53248
    ds_read_b64_tr_b16 v[218:219], v14 offset:53760
    s_and_b32 s96, s92, 2
    s_lshl_b32 s96, s96, 8
    s_add_u32 s51, s51, s96
    s_mul_i32 s96, s3, 43008
    s_add_u32 s90, s90, s96
    s_add_u32 s51, s51, 16777216
    s_lshl_b32 s52, s91, 8
    s_lshl_b32 s96, s92, 2
    s_waitcnt lgkmcnt(5)
    v_mfma_f32_32x32x16_bf16 v[144:159], v[208:211], v[116:119], v[144:159]
    ds_read_b64_tr_b16 v[220:221], v14 offset:61440
    ds_read_b64_tr_b16 v[222:223], v14 offset:61952
    s_add_u32 m0, s6, 81920
    s_add_u32 s12, s12, 0x38000
    buffer_load_dwordx4 v4, s[60:63], s12 offen lds
    s_add_u32 s52, s52, s96
    s_add_u32 s52, s52, 12288
    s_cmp_eq_u32 s101, 7
    s_cselect_b32 s66, 0, s66
    s_mov_b32 s32, 0
    s_not_b32 s33, s84
    s_waitcnt lgkmcnt(5)
    v_mfma_f32_32x32x16_bf16 v[160:175], v[212:215], v[116:119], v[160:175]
    ds_read_b64_tr_b16 v[208:209], v15 offset:4096
    ds_read_b64_tr_b16 v[210:211], v15 offset:4608
    s_add_u32 m0, s6, 16384
    s_add_u32 s11, s11, 0x38000
    buffer_load_dwordx4 v4, s[56:59], s11 offen lds
    s_and_b32 s14, s3, 3
    s_lshr_b32 s94, s3, 2
    s_lshl_b32 s95, s93, 1
    s_add_u32 s95, s95, s94
    s_mul_i32 s53, s95, 114688
    s_waitcnt lgkmcnt(4)
    v_mfma_f32_32x32x16_bf16 v[128:143], v[216:219], v[120:123], v[128:143]
    ds_read_b64_tr_b16 v[212:213], v14 offset:55296
    ds_read_b64_tr_b16 v[214:215], v14 offset:55808
    s_mul_i32 s96, s14, 28672
    s_add_u32 s53, s53, s96
    s_add_u32 s53, s53, 8388608
    s_cmp_eq_u32 s101, 7
    s_cselect_b32 s53, 33554432, s53
    s_waitcnt lgkmcnt(4)
    v_mfma_f32_32x32x16_bf16 v[144:159], v[220:223], v[120:123], v[144:159]
    ds_read_b64_tr_b16 v[216:217], v14 offset:63488
    ds_read_b64_tr_b16 v[218:219], v14 offset:64000
    s_add_u32 m0, s6, 24576
    s_add_u32 s12, s12, 0x38000
    buffer_load_dwordx4 v4, s[60:63], s12 offen lds
    s_mul_i32 s54, s95, 32768
    s_and_b32 s96, s14, 1
    s_mul_i32 s96, s96, 14336
    s_add_u32 s54, s54, s96
    s_add_u32 s54, s54, 16777216
    s_mul_i32 s55, s95, 28672
    s_waitcnt lgkmcnt(4)
    v_mfma_f32_32x32x16_bf16 v[160:175], v[208:211], v[120:123], v[160:175]
    ds_read_b64_tr_b16 v[220:221], v15 offset:6144
    ds_read_b64_tr_b16 v[222:223], v15 offset:6656
    s_lshl_b32 s96, s101, 7
    s_add_u32 s55, s55, s96
    s_lshl_b32 s96, s14, 5
    s_add_u32 s55, s55, s96
    s_waitcnt lgkmcnt(4)
    v_mfma_f32_32x32x16_bf16 v[128:143], v[212:215], v[124:127], v[128:143]
    s_waitcnt vmcnt(8)
    s_barrier
    ds_read_b64_tr_b16 v[208:209], v13 offset:49152
    ds_read_b64_tr_b16 v[210:211], v13 offset:49664
    v_mov_b32 v252, v248
    v_mov_b32 v253, v248
    v_mov_b32 v254, v248
    v_mov_b32 v255, v248
    v_lshrrev_b32 v228, 4, v1
    v_and_b32 v229, 15, v1
    s_lshr_b32 s94, s3, 1
    s_lshl_b32 s94, s94, 11
    s_and_b32 s95, s3, 1
    s_lshl_b32 s96, s95, 8
    s_add_u32 s94, s94, s96
    s_add_u32 s94, s94, 114688
    s_mul_i32 s95, s95, 1536
    s_add_u32 s95, s95, 256
    v_lshlrev_b32 v230, 4, v229
    s_waitcnt lgkmcnt(4)
    v_mfma_f32_32x32x16_bf16 v[144:159], v[216:219], v[124:127], v[144:159]
    ds_read_b64_tr_b16 v[212:213], v13 offset:51200
    ds_read_b64_tr_b16 v[214:215], v13 offset:51712
    s_add_u32 m0, s6, 90112
    s_add_u32 s11, s11, 0x38000
    buffer_load_dwordx4 v4, s[56:59], s11 offen lds
    v_lshl_add_u32 v3, v228, 9, v230
    v_add_u32 v9, s94, v3
    v_add_u32 v10, s95, v9
    v_lshrrev_b32 v231, 5, v1
    v_lshlrev_b32 v232, 7, v231
    s_waitcnt lgkmcnt(4)
    v_mfma_f32_32x32x16_bf16 v[160:175], v[220:223], v[124:127], v[160:175]
    ds_read_b64_tr_b16 v[216:217], v13 offset:53248
    ds_read_b64_tr_b16 v[218:219], v13 offset:53760
    s_add_u32 m0, s6, 98304
    s_add_u32 s12, s12, 0x38000
    buffer_load_dwordx4 v4, s[60:63], s12 offen lds
    v_xor_b32 v7, v232, v2
    v_and_b32 v232, 1, v228
    s_and_b32 s96, s92, 1
    s_mul_i32 s96, s96, 3
    v_lshl_add_u32 v231, v232, 1, v231
    v_add_u32 v231, s96, v231
    v_lshl_add_u32 v5, v231, 10, v230
    s_and_b32 s96, s92, 1
    s_lshl_b32 s96, s96, 1
    s_and_b32 s97, s3, 1
    s_sub_u32 s96, s96, s97
    s_lshl_b32 s96, s96, 7
    s_add_u32 s96, s96, 3072
    v_lshl_add_u32 v230, v229, 3, s96
    s_waitcnt lgkmcnt(4)
    v_mfma_f32_32x32x16_bf16 v[128:143], v[208:211], v[252:255], v[128:143]
    ds_read_b64_tr_b16 v[220:221], v13 offset:55296
    ds_read_b64_tr_b16 v[222:223], v13 offset:55808
    v_cmp_eq_u32 vcc, 3, v231
    s_nop 1
    v_cndmask_b32 v5, v5, v230, vcc
    v_bfe_u32 v230, v1, 1, 1
    v_lshrrev_b32 v231, 2, v1
    v_lshlrev_b32 v232, 3, v230
    s_waitcnt lgkmcnt(4)
    v_mfma_f32_32x32x16_bf16 v[144:159], v[212:215], v[252:255], v[144:159]
    ds_read_b64_tr_b16 v[208:209], v13 offset:57344
    ds_read_b64_tr_b16 v[210:211], v13 offset:57856
    s_add_u32 m0, s6, 106496
    s_add_u32 s11, s11, 0x38000
    buffer_load_dwordx4 v4, s[56:59], s11 offen lds
    v_xor_b32 v231, v231, v232
    v_lshlrev_b32 v231, 4, v231
    v_lshl_add_u32 v231, v230, 9, v231
    v_and_b32 v230, 1, v1
    v_lshl_add_u32 v231, v230, 3, v231
    s_waitcnt lgkmcnt(4)
    v_mfma_f32_32x32x16_bf16 v[160:175], v[216:219], v[252:255], v[160:175]
    ds_read_b64_tr_b16 v[212:213], v15 offset:8192
    ds_read_b64_tr_b16 v[214:215], v15 offset:8704
    s_add_u32 s94, s94, 24576
    v_add_u32 v11, s94, v231
    v_add_u32 v12, s95, v11
    v_and_b32 v231, 3, v1
    v_min_u32 v230, 2, v228
    v_cmp_eq_u32 vcc, 0, v231
    v_min_u32 v229, 2, v231
    s_nop 0
    v_cndmask_b32 v230, v230, 2, vcc
    s_waitcnt lgkmcnt(4)
    v_mfma_f32_32x32x16_bf16 v[176:191], v[220:223], v[252:255], 0
    ds_read_b64_tr_b16 v[216:217], v15 offset:16384
    ds_read_b64_tr_b16 v[218:219], v15 offset:16896
    s_add_u32 m0, s6, 32768
    s_add_u32 s12, s12, 0x38000
    buffer_load_dwordx4 v4, s[60:63], s12 offen lds
    s_sub_u32 s96, s91, 2
    v_add_u32 v230, s96, v230
    s_lshr_b32 s96, s92, 1
    v_lshl_add_u32 v229, v229, 3, s96
    v_max_i32 v230, 0, v230
    v_mul_u32_u24 v232, 43, v229
    v_lshrrev_b32 v232, 7, v232
    s_waitcnt lgkmcnt(4)
    v_mfma_f32_32x32x16_bf16 v[192:207], v[208:211], v[252:255], 0
    ds_read_b64_tr_b16 v[220:221], v15 offset:10240
    ds_read_b64_tr_b16 v[222:223], v15 offset:10752
    v_add_u32 v232, 8, v232
    v_cmp_gt_u32 vcc, 12, v229
    v_lshlrev_b32 v230, 8, v230
    s_nop 0
    v_cndmask_b32 v229, v232, v229, vcc
    v_lshl_add_u32 v230, v229, 2, v230
    s_cmp_lt_u32 s91, 2
    s_cselect_b32 s96, 3, 4
    v_cmp_eq_u32 vcc, s96, v231
    s_nop 1
    v_cndmask_b32 v8, v230, 0, vcc
    s_cmp_ge_u32 s5, 12
    s_cbranch_scc1 L_typec
    s_waitcnt lgkmcnt(4)
    v_mfma_f32_32x32x16_bf16 v[176:191], v[212:215], v[16:19], v[176:191]
    ds_read_b64_tr_b16 v[208:209], v15 offset:18432
    ds_read_b64_tr_b16 v[210:211], v15 offset:18944
    v_mov_b32 v240, s79
    v_mul_f32 v128, v249, v128
    v_mul_f32 v129, v249, v129
    v_mul_f32 v130, v249, v130
    s_waitcnt lgkmcnt(4)
    v_mfma_f32_32x32x16_bf16 v[192:207], v[216:219], v[16:19], v[192:207]
    ds_read_b64_tr_b16 v[212:213], v15 offset:12288
    ds_read_b64_tr_b16 v[214:215], v15 offset:12800
    v_mul_f32 v131, v249, v131
    v_mul_f32 v132, v249, v132
    v_mul_f32 v133, v249, v133
    v_mul_f32 v134, v249, v134
    v_mul_f32 v135, v249, v135
    s_waitcnt lgkmcnt(4)
    v_mfma_f32_32x32x16_bf16 v[176:191], v[220:223], v[20:23], v[176:191]
    ds_read_b64_tr_b16 v[216:217], v15 offset:20480
    ds_read_b64_tr_b16 v[218:219], v15 offset:20992
    v_mul_f32 v136, v249, v136
    v_mul_f32 v137, v249, v137
    v_mul_f32 v138, v249, v138
    v_mul_f32 v139, v249, v139
    v_mul_f32 v140, v249, v140
    v_mul_f32 v141, v249, v141
    s_waitcnt lgkmcnt(4)
    v_mfma_f32_32x32x16_bf16 v[192:207], v[208:211], v[20:23], v[192:207]
    ds_read_b64_tr_b16 v[220:221], v15 offset:14336
    ds_read_b64_tr_b16 v[222:223], v15 offset:14848
    v_mul_f32 v142, v249, v142
    v_mul_f32 v143, v249, v143
    v_cvt_pk_bf16_f32 v224, v128, v129
    v_cvt_pk_bf16_f32 v225, v130, v131
    v_cvt_pk_bf16_f32 v226, v132, v133
    s_waitcnt lgkmcnt(4)
    v_mfma_f32_32x32x16_bf16 v[176:191], v[212:215], v[24:27], v[176:191]
    ds_read_b64_tr_b16 v[208:209], v15 offset:22528
    ds_read_b64_tr_b16 v[210:211], v15 offset:23040
    v_cvt_pk_bf16_f32 v227, v134, v135
    v_cvt_pk_bf16_f32 v228, v136, v137
    v_cvt_pk_bf16_f32 v229, v138, v139
    v_cvt_pk_bf16_f32 v230, v140, v141
    v_cvt_pk_bf16_f32 v231, v142, v143
    s_waitcnt lgkmcnt(4)
    v_mfma_f32_32x32x16_bf16 v[192:207], v[216:219], v[24:27], v[192:207]
    s_waitcnt vmcnt(10)
    s_barrier
    ds_read_b64_tr_b16 v[212:213], v15 offset:24576
    ds_read_b64_tr_b16 v[214:215], v15 offset:25088
    v_cndmask_b32 v224, v224, v240, s[84:85]
    v_cndmask_b32 v225, v225, 0, s[84:85]
    v_cndmask_b32 v230, v230, v240, s[32:33]
    v_cndmask_b32 v231, v231, 0, s[32:33]
    v_permlane32_swap_b32 v224, v226
    s_waitcnt lgkmcnt(4)
    v_mfma_f32_32x32x16_bf16 v[176:191], v[220:223], v[28:31], v[176:191]
    ds_read_b64_tr_b16 v[216:217], v13 offset:0
    ds_read_b64_tr_b16 v[218:219], v13 offset:512
    s_add_u32 m0, s6, 40960
    s_nop 0
    buffer_load_dwordx4 v6, s[64:67], s89 offen lds
    v_permlane32_swap_b32 v225, v227
    v_permlane32_swap_b32 v228, v230
    v_permlane32_swap_b32 v229, v231
    buffer_store_dwordx4 v[224:227], v2, s[40:43], s76 offen offset:0 sc1
    buffer_store_dwordx4 v[228:231], v2, s[40:43], s76 offen offset:1024 sc1
    s_waitcnt lgkmcnt(4)
    v_mfma_f32_32x32x16_bf16 v[192:207], v[208:211], v[28:31], v[192:207]
    ds_read_b64_tr_b16 v[220:221], v15 offset:26624
    ds_read_b64_tr_b16 v[222:223], v15 offset:27136
    v_mul_f32 v240, v250, v144
    v_mul_f32 v241, v250, v145
    v_mul_f32 v242, v250, v146
    v_mul_f32 v243, v250, v147
    v_exp_f32 v240, v240
    s_waitcnt lgkmcnt(4)
    v_mfma_f32_32x32x16_bf16 v[176:191], v[212:215], v[112:115], v[176:191]
    ds_read_b64_tr_b16 v[208:209], v13 offset:2048
    ds_read_b64_tr_b16 v[210:211], v13 offset:2560
    s_add_u32 m0, s6, 49152
    s_add_u32 s89, s89, 57344
    buffer_load_dwordx4 v6, s[64:67], s89 offen lds
    v_exp_f32 v241, v241
    v_exp_f32 v242, v242
    v_exp_f32 v243, v243
    v_mul_f32 v144, v144, v160
    v_mul_f32 v145, v145, v161
    s_waitcnt lgkmcnt(4)
    v_mfma_f32_32x32x16_bf16 v[192:207], v[216:219], v[112:115], v[192:207]
    ds_read_b64_tr_b16 v[212:213], v15 offset:28672
    ds_read_b64_tr_b16 v[214:215], v15 offset:29184
    v_mul_f32 v146, v146, v162
    v_mul_f32 v147, v147, v163
    v_fma_f32 v240, v240, v251, v251
    v_fma_f32 v241, v241, v251, v251
    v_fma_f32 v242, v242, v251, v251
    s_waitcnt lgkmcnt(4)
    v_mfma_f32_32x32x16_bf16 v[176:191], v[220:223], v[116:119], v[176:191]
    ds_read_b64_tr_b16 v[216:217], v13 offset:4096
    ds_read_b64_tr_b16 v[218:219], v13 offset:4608
    s_add_u32 m0, s6, 57344
    s_add_u32 s89, s89, 57344
    buffer_load_dwordx4 v6, s[64:67], s89 offen lds
    v_fma_f32 v243, v243, v251, v251
    v_rcp_f32 v240, v240
    v_rcp_f32 v241, v241
    v_rcp_f32 v242, v242
    v_rcp_f32 v243, v243
    s_waitcnt lgkmcnt(4)
    v_mfma_f32_32x32x16_bf16 v[192:207], v[208:211], v[116:119], v[192:207]
    ds_read_b64_tr_b16 v[220:221], v15 offset:30720
    ds_read_b64_tr_b16 v[222:223], v15 offset:31232
    v_mul_f32 v144, v144, v240
    v_mul_f32 v145, v145, v241
    v_mul_f32 v146, v146, v242
    v_mul_f32 v147, v147, v243
    v_cvt_pk_bf16_f32 v224, v144, v145
    s_waitcnt lgkmcnt(4)
    v_mfma_f32_32x32x16_bf16 v[176:191], v[212:215], v[120:123], v[176:191]
    ds_read_b64_tr_b16 v[208:209], v13 offset:6144
    ds_read_b64_tr_b16 v[210:211], v13 offset:6656
    v_cvt_pk_bf16_f32 v225, v146, v147
    v_mul_f32 v244, v250, v148
    v_mul_f32 v245, v250, v149
    v_mul_f32 v246, v250, v150
    v_mul_f32 v247, v250, v151
    s_waitcnt lgkmcnt(4)
    v_mfma_f32_32x32x16_bf16 v[192:207], v[216:219], v[120:123], v[192:207]
    s_waitcnt vmcnt(13)
    s_barrier
    ds_read_b64_tr_b16 v[212:213], v13 offset:8192
    ds_read_b64_tr_b16 v[214:215], v13 offset:8704
    v_exp_f32 v244, v244
    v_exp_f32 v245, v245
    v_exp_f32 v246, v246
    v_exp_f32 v247, v247
    v_mul_f32 v148, v148, v164
    s_waitcnt lgkmcnt(4)
    v_mfma_f32_32x32x16_bf16 v[176:191], v[220:223], v[124:127], v[176:191]
    ds_read_b64_tr_b16 v[216:217], v14 offset:0
    ds_read_b64_tr_b16 v[218:219], v14 offset:512
    s_add_u32 m0, s6, 0
    s_add_u32 s89, s89, 57344
    buffer_load_dwordx4 v6, s[64:67], s89 offen lds
    v_mul_f32 v149, v149, v165
    v_mul_f32 v150, v150, v166
    v_mul_f32 v151, v151, v167
    v_fma_f32 v244, v244, v251, v251
    v_fma_f32 v245, v245, v251, v251
    s_waitcnt lgkmcnt(4)
    v_mfma_f32_32x32x16_bf16 v[192:207], v[208:211], v[124:127], v[192:207]
    ds_read_b64_tr_b16 v[220:221], v13 offset:10240
    ds_read_b64_tr_b16 v[222:223], v13 offset:10752
    v_fma_f32 v246, v246, v251, v251
    v_fma_f32 v247, v247, v251, v251
    v_rcp_f32 v244, v244
    v_rcp_f32 v245, v245
    v_rcp_f32 v246, v246
    s_waitcnt lgkmcnt(4)
    v_mfma_f32_32x32x16_bf16 v[176:191], v[212:215], v[32:35], v[176:191]
    ds_read_b64_tr_b16 v[208:209], v14 offset:2048
    ds_read_b64_tr_b16 v[210:211], v14 offset:2560
    v_rcp_f32 v247, v247
    v_mul_f32 v148, v148, v244
    v_mul_f32 v149, v149, v245
    v_mul_f32 v150, v150, v246
    v_mul_f32 v151, v151, v247
    s_waitcnt lgkmcnt(4)
    v_mfma_f32_32x32x16_bf16 v[192:207], v[216:219], v[32:35], v[192:207]
    ds_read_b64_tr_b16 v[212:213], v13 offset:12288
    ds_read_b64_tr_b16 v[214:215], v13 offset:12800
    v_cvt_pk_bf16_f32 v226, v148, v149
    v_cvt_pk_bf16_f32 v227, v150, v151
    buffer_store_dwordx4 v[224:227], v2, s[40:43], s82 offen sc1
    v_mul_f32 v240, v250, v152
    v_mul_f32 v241, v250, v153
    s_waitcnt lgkmcnt(4)
    v_mfma_f32_32x32x16_bf16 v[176:191], v[220:223], v[36:39], v[176:191]
    ds_read_b64_tr_b16 v[216:217], v14 offset:4096
    ds_read_b64_tr_b16 v[218:219], v14 offset:4608
    v_mul_f32 v242, v250, v154
    v_mul_f32 v243, v250, v155
    v_exp_f32 v240, v240
    v_exp_f32 v241, v241
    v_exp_f32 v242, v242
    s_waitcnt lgkmcnt(4)
    v_mfma_f32_32x32x16_bf16 v[192:207], v[208:211], v[36:39], v[192:207]
    ds_read_b64_tr_b16 v[220:221], v13 offset:14336
    ds_read_b64_tr_b16 v[222:223], v13 offset:14848
    v_exp_f32 v243, v243
    v_mul_f32 v152, v152, v168
    v_mul_f32 v153, v153, v169
    v_mul_f32 v154, v154, v170
    v_mul_f32 v155, v155, v171
    s_waitcnt lgkmcnt(4)
    v_mfma_f32_32x32x16_bf16 v[176:191], v[212:215], v[40:43], v[176:191]
    ds_read_b64_tr_b16 v[208:209], v14 offset:6144
    ds_read_b64_tr_b16 v[210:211], v14 offset:6656
    v_fma_f32 v240, v240, v251, v251
    v_fma_f32 v241, v241, v251, v251
    v_fma_f32 v242, v242, v251, v251
    v_fma_f32 v243, v243, v251, v251
    v_rcp_f32 v240, v240
    s_waitcnt lgkmcnt(4)
    v_mfma_f32_32x32x16_bf16 v[192:207], v[216:219], v[40:43], v[192:207]
    s_waitcnt vmcnt(4)
    s_barrier
    ds_read_b64_tr_b16 v[212:213], v14 offset:8192
    ds_read_b64_tr_b16 v[214:215], v14 offset:8704
    s_cmp_lg_u32 s3, 0
    s_cbranch_scc1 L_sig_11
    v_mov_b32 v17, s7
    s_mov_b64 exec, 1
    s_add_u32 s97, s83, 0
    buffer_store_dword v17, off, s[40:43], s97 sc1
    s_mov_b64 exec, -1
L_sig_11:
    v_rcp_f32 v241, v241
    v_rcp_f32 v242, v242
    v_rcp_f32 v243, v243
    v_mul_f32 v152, v152, v240
    v_mul_f32 v153, v153, v241
    s_waitcnt lgkmcnt(4)
    v_mfma_f32_32x32x16_bf16 v[176:191], v[220:223], v[44:47], v[176:191]
    ds_read_b64_tr_b16 v[216:217], v14 offset:16384
    ds_read_b64_tr_b16 v[218:219], v14 offset:16896
    s_add_u32 m0, s6, 8192
    s_add_u32 s89, s89, 57344
    buffer_load_dwordx4 v6, s[64:67], s89 offen lds
    v_mul_f32 v154, v154, v242
    v_mul_f32 v155, v155, v243
    v_cvt_pk_bf16_f32 v232, v152, v153
    v_cvt_pk_bf16_f32 v233, v154, v155
    s_waitcnt lgkmcnt(4)
    v_mfma_f32_32x32x16_bf16 v[192:207], v[208:211], v[44:47], v[192:207]
    ds_read_b64_tr_b16 v[220:221], v14 offset:10240
    ds_read_b64_tr_b16 v[222:223], v14 offset:10752
    v_mul_f32 v244, v250, v156
    v_mul_f32 v245, v250, v157
    v_mul_f32 v246, v250, v158
    v_mul_f32 v247, v250, v159
    v_exp_f32 v244, v244
    s_waitcnt lgkmcnt(4)
    v_mfma_f32_32x32x16_bf16 v[176:191], v[212:215], v[48:51], v[176:191]
    ds_read_b64_tr_b16 v[208:209], v14 offset:18432
    ds_read_b64_tr_b16 v[210:211], v14 offset:18944
    s_add_u32 m0, s6, 65536
    s_add_u32 s89, s89, 57344
    buffer_load_dwordx4 v6, s[64:67], s89 offen lds
    v_exp_f32 v245, v245
    v_exp_f32 v246, v246
    v_exp_f32 v247, v247
    v_mul_f32 v156, v156, v172
    s_waitcnt lgkmcnt(4)
    v_mfma_f32_32x32x16_bf16 v[192:207], v[216:219], v[48:51], v[192:207]
    ds_read_b64_tr_b16 v[212:213], v14 offset:12288
    ds_read_b64_tr_b16 v[214:215], v14 offset:12800
    v_mul_f32 v157, v157, v173
    v_mul_f32 v158, v158, v174
    v_mul_f32 v159, v159, v175
    v_fma_f32 v244, v244, v251, v251
    v_fma_f32 v245, v245, v251, v251
    s_waitcnt lgkmcnt(4)
    v_mfma_f32_32x32x16_bf16 v[176:191], v[220:223], v[52:55], v[176:191]
    ds_read_b64_tr_b16 v[216:217], v14 offset:20480
    ds_read_b64_tr_b16 v[218:219], v14 offset:20992
    s_add_u32 s97, s89, 688128
    buffer_load_dwordx4 v[112:115], v6, s[64:67], s97 offen
    v_fma_f32 v246, v246, v251, v251
    v_fma_f32 v247, v247, v251, v251
    v_rcp_f32 v244, v244
    v_rcp_f32 v245, v245
    s_waitcnt lgkmcnt(4)
    v_mfma_f32_32x32x16_bf16 v[192:207], v[208:211], v[52:55], v[192:207]
    ds_read_b64_tr_b16 v[220:221], v14 offset:14336
    ds_read_b64_tr_b16 v[222:223], v14 offset:14848
    v_rcp_f32 v246, v246
    v_rcp_f32 v247, v247
    v_mul_f32 v156, v156, v244
    v_mul_f32 v157, v157, v245
    v_mul_f32 v158, v158, v246
    s_waitcnt lgkmcnt(4)
    v_mfma_f32_32x32x16_bf16 v[176:191], v[212:215], v[56:59], v[176:191]
    ds_read_b64_tr_b16 v[208:209], v14 offset:22528
    ds_read_b64_tr_b16 v[210:211], v14 offset:23040
    v_mul_f32 v159, v159, v247
    v_cvt_pk_bf16_f32 v234, v156, v157
    v_cvt_pk_bf16_f32 v235, v158, v159
    buffer_store_dwordx4 v[232:235], v0, s[40:43], s82 offen sc1
    s_waitcnt lgkmcnt(4)
    v_mfma_f32_32x32x16_bf16 v[192:207], v[216:219], v[56:59], v[192:207]
    s_barrier
    ds_read_b64_tr_b16 v[212:213], v13 offset:16384
    ds_read_b64_tr_b16 v[214:215], v13 offset:16896
    v_lshrrev_b32 v20, 2, v1
    v_and_b32 v20, 12, v20
    s_waitcnt lgkmcnt(4)
    v_mfma_f32_32x32x16_bf16 v[176:191], v[220:223], v[60:63], v[176:191]
    ds_read_b64_tr_b16 v[216:217], v13 offset:24576
    ds_read_b64_tr_b16 v[218:219], v13 offset:25088
    s_add_u32 m0, s6, 73728
    s_add_u32 s89, s89, 57344
    buffer_load_dwordx4 v6, s[64:67], s89 offen lds
    v_and_b32 v21, 15, v1
    s_waitcnt lgkmcnt(4)
    v_mfma_f32_32x32x16_bf16 v[192:207], v[208:211], v[60:63], v[192:207]
    ds_read_b64_tr_b16 v[220:221], v13 offset:18432
    ds_read_b64_tr_b16 v[222:223], v13 offset:18944
    v_sub_u32 v20, v21, v20
    s_waitcnt lgkmcnt(4)
    v_mfma_f32_32x32x16_bf16 v[176:191], v[212:215], v[64:67], v[176:191]
    ds_read_b64_tr_b16 v[208:209], v13 offset:26624
    ds_read_b64_tr_b16 v[210:211], v13 offset:27136
    s_add_u32 m0, s6, 81920
    s_add_u32 s89, s89, 57344
    buffer_load_dwordx4 v6, s[64:67], s89 offen lds
    v_mov_b32 v21, 4048155338
    s_waitcnt lgkmcnt(4)
    v_mfma_f32_32x32x16_bf16 v[192:207], v[216:219], v[64:67], v[192:207]
    ds_read_b64_tr_b16 v[212:213], v13 offset:20480
    ds_read_b64_tr_b16 v[214:215], v13 offset:20992
    v_cmp_gt_i32 vcc, 0, v20
    s_nop 1
    v_cndmask_b32 v132, v21, 0, vcc
    v_cndmask_b32 v128, 0, v21, vcc
    s_waitcnt lgkmcnt(4)
    v_mfma_f32_32x32x16_bf16 v[176:191], v[220:223], v[68:71], v[176:191]
    ds_read_b64_tr_b16 v[216:217], v13 offset:28672
    ds_read_b64_tr_b16 v[218:219], v13 offset:29184
    s_add_u32 s97, s89, 630784
    buffer_load_dwordx4 v[116:119], v6, s[64:67], s97 offen
    v_cmp_gt_i32 vcc, 1, v20
    s_nop 1
    v_cndmask_b32 v133, v21, 0, vcc
    v_cndmask_b32 v129, 0, v21, vcc
    s_waitcnt lgkmcnt(4)
    v_mfma_f32_32x32x16_bf16 v[192:207], v[208:211], v[68:71], v[192:207]
    ds_read_b64_tr_b16 v[220:221], v13 offset:22528
    ds_read_b64_tr_b16 v[222:223], v13 offset:23040
    v_cmp_gt_i32 vcc, 2, v20
    s_nop 1
    v_cndmask_b32 v134, v21, 0, vcc
    v_cndmask_b32 v130, 0, v21, vcc
    s_waitcnt lgkmcnt(4)
    v_mfma_f32_32x32x16_bf16 v[176:191], v[212:215], v[72:75], v[176:191]
    ds_read_b64_tr_b16 v[208:209], v13 offset:30720
    ds_read_b64_tr_b16 v[210:211], v13 offset:31232
    v_cmp_gt_i32 vcc, 3, v20
    s_nop 1
    v_cndmask_b32 v135, v21, 0, vcc
    v_cndmask_b32 v131, 0, v21, vcc
    s_waitcnt lgkmcnt(4)
    v_mfma_f32_32x32x16_bf16 v[192:207], v[216:219], v[72:75], v[192:207]
    s_barrier
    ds_read_b64_tr_b16 v[212:213], v14 offset:24576
    ds_read_b64_tr_b16 v[214:215], v14 offset:25088
    s_mov_b32 s97, 0x0b0b0909
    v_perm_b32 v60, v129, v128, s97
    v_perm_b32 v61, v131, v130, s97
    s_waitcnt lgkmcnt(4)
    v_mfma_f32_32x32x16_bf16 v[176:191], v[220:223], v[76:79], v[176:191]
    ds_read_b64_tr_b16 v[216:217], v14 offset:32768
    ds_read_b64_tr_b16 v[218:219], v14 offset:33280
    s_add_u32 m0, s6, 16384
    s_add_u32 s89, s89, 57344
    buffer_load_dwordx4 v6, s[64:67], s89 offen lds
    s_waitcnt lgkmcnt(4)
    v_mfma_f32_32x32x16_bf16 v[192:207], v[208:211], v[76:79], v[192:207]
    ds_read_b64_tr_b16 v[220:221], v14 offset:26624
    ds_read_b64_tr_b16 v[222:223], v14 offset:27136
    s_waitcnt lgkmcnt(4)
    v_mfma_f32_32x32x16_bf16 v[176:191], v[212:215], v[80:83], v[176:191]
    ds_read_b64_tr_b16 v[208:209], v14 offset:34816
    ds_read_b64_tr_b16 v[210:211], v14 offset:35328
    s_add_u32 m0, s6, 24576
    s_add_u32 s89, s89, 57344
    buffer_load_dwordx4 v6, s[64:67], s89 offen lds
    s_waitcnt lgkmcnt(4)
    v_mfma_f32_32x32x16_bf16 v[192:207], v[216:219], v[80:83], v[192:207]
    ds_read_b64_tr_b16 v[212:213], v14 offset:28672
    ds_read_b64_tr_b16 v[214:215], v14 offset:29184
    s_waitcnt lgkmcnt(4)
    v_mfma_f32_32x32x16_bf16 v[176:191], v[220:223], v[84:87], v[176:191]
    ds_read_b64_tr_b16 v[216:217], v14 offset:36864
    ds_read_b64_tr_b16 v[218:219], v14 offset:37376
    s_add_u32 s97, s89, 573440
    buffer_load_dwordx4 v[120:123], v6, s[64:67], s97 offen
    s_waitcnt lgkmcnt(4)
    v_mfma_f32_32x32x16_bf16 v[192:207], v[208:211], v[84:87], v[192:207]
    ds_read_b64_tr_b16 v[220:221], v14 offset:30720
    ds_read_b64_tr_b16 v[222:223], v14 offset:31232
    s_waitcnt lgkmcnt(4)
    v_mfma_f32_32x32x16_bf16 v[176:191], v[212:215], v[88:91], v[176:191]
    ds_read_b64_tr_b16 v[208:209], v14 offset:38912
    ds_read_b64_tr_b16 v[210:211], v14 offset:39424
    s_waitcnt lgkmcnt(4)
    v_mfma_f32_32x32x16_bf16 v[192:207], v[216:219], v[88:91], v[192:207]
    s_waitcnt vmcnt(6)
    s_barrier
    ds_read_b64_tr_b16 v[212:213], v14 offset:40960
    ds_read_b64_tr_b16 v[214:215], v14 offset:41472
    s_cmp_lg_u32 s3, 0
    s_cbranch_scc1 L_sig_12
    v_mov_b32 v17, s7
    s_mov_b64 exec, 1
    s_add_u32 s97, s83, 4096
    buffer_store_dword v17, off, s[40:43], s97 sc1
    s_mov_b64 exec, -1
L_sig_12:
    buffer_load_dword v16, v8, s[40:43], 0 offen sc1
    s_waitcnt lgkmcnt(4)
    v_mfma_f32_32x32x16_bf16 v[176:191], v[220:223], v[92:95], v[176:191]
    ds_read_b64_tr_b16 v[216:217], v13 offset:32768
    ds_read_b64_tr_b16 v[218:219], v13 offset:33280
    s_add_u32 m0, s6, 90112
    s_add_u32 s89, s89, 57344
    buffer_load_dwordx4 v6, s[64:67], s89 offen lds
    s_waitcnt lgkmcnt(4)
    v_mfma_f32_32x32x16_bf16 v[192:207], v[208:211], v[92:95], v[192:207]
    ds_read_b64_tr_b16 v[220:221], v14 offset:43008
    ds_read_b64_tr_b16 v[222:223], v14 offset:43520
    s_waitcnt lgkmcnt(4)
    v_mfma_f32_32x32x16_bf16 v[176:191], v[212:215], v[96:99], v[176:191]
    ds_read_b64_tr_b16 v[208:209], v13 offset:34816
    ds_read_b64_tr_b16 v[210:211], v13 offset:35328
    s_waitcnt lgkmcnt(4)
    v_mfma_f32_32x32x16_bf16 v[192:207], v[216:219], v[96:99], v[192:207]
    ds_read_b64_tr_b16 v[212:213], v14 offset:45056
    ds_read_b64_tr_b16 v[214:215], v14 offset:45568
    s_add_u32 m0, s6, 98304
    s_add_u32 s89, s89, 57344
    buffer_load_dwordx4 v6, s[64:67], s89 offen lds
    s_waitcnt lgkmcnt(4)
    v_mfma_f32_32x32x16_bf16 v[176:191], v[220:223], v[100:103], v[176:191]
    ds_read_b64_tr_b16 v[216:217], v13 offset:36864
    ds_read_b64_tr_b16 v[218:219], v13 offset:37376
    s_waitcnt lgkmcnt(4)
    v_mfma_f32_32x32x16_bf16 v[192:207], v[208:211], v[100:103], v[192:207]
    ds_read_b64_tr_b16 v[220:221], v14 offset:47104
    ds_read_b64_tr_b16 v[222:223], v14 offset:47616
    s_waitcnt lgkmcnt(4)
    v_mfma_f32_32x32x16_bf16 v[176:191], v[212:215], v[104:107], v[176:191]
    ds_read_b64_tr_b16 v[208:209], v13 offset:38912
    ds_read_b64_tr_b16 v[210:211], v13 offset:39424
    s_waitcnt vmcnt(2)
    v_cmp_ne_u32 vcc, s7, v16
    s_nop 0
    s_cmp_lg_u64 vcc, 0
    s_cbranch_scc1 L_spin_9
L_back_10:
    buffer_load_dwordx4 v[252:255], v3, s[40:43], s47 offen sc1
    s_waitcnt lgkmcnt(4)
    v_mfma_f32_32x32x16_bf16 v[192:207], v[216:219], v[104:107], v[192:207]
    s_barrier
    s_add_u32 m0, s6, 114688
    s_nop 0
    buffer_load_dwordx4 v2, s[40:43], s44 offen sc1 lds
    s_waitcnt lgkmcnt(2)
    v_mfma_f32_32x32x16_bf16 v[176:191], v[220:223], v[108:111], v[176:191]
    s_add_u32 m0, s6, 122880
    s_nop 0
    buffer_load_dwordx4 v2, s[40:43], s45 offen sc1 lds
    s_waitcnt lgkmcnt(0)
    v_mfma_f32_32x32x16_bf16 v[192:207], v[208:211], v[108:111], v[192:207]
    s_add_u32 m0, s6, 131072
    s_nop 0
    buffer_load_dwordx4 v2, s[40:43], s46 offen sc1 lds
L_join:
    s_load_dwordx2 s[72:73], s[0:1], 56
    s_add_u32 s82, s82, 12288
    v_and_b32 v4, 15, v1
    s_lshr_b32 s94, s93, 1
    s_lshl_b32 s94, s94, 8
    s_add_u32 s94, s94, 4096
    s_cmp_eq_u32 s101, 7
    s_cselect_b32 s94, s83, s94
    s_cselect_b32 s95, 0, 4
    v_mul_u32_u24 v4, s95, v4
    s_movk_i32 s100, 4096
    v_add_u32 v4, s94, v4
    s_setprio 0
    v_mov_b32 v248, v251
    v_mul_f32 v240, v250, v176
    v_mul_f32 v241, v250, v177
    v_mul_f32 v242, v250, v178
    v_mul_f32 v243, v250, v179
    s_setprio 1
    v_exp_f32 v240, v240
    v_exp_f32 v241, v241
    v_exp_f32 v242, v242
    v_exp_f32 v243, v243
    s_setprio 0
    v_mul_f32 v176, v176, v192
    v_mul_f32 v177, v177, v193
    v_mul_f32 v178, v178, v194
    v_mul_f32 v179, v179, v195
    v_fma_f32 v240, v240, v251, v248
    v_fma_f32 v241, v241, v251, v248
    v_fma_f32 v242, v242, v251, v248
    v_fma_f32 v243, v243, v251, v248
    s_setprio 1
    s_add_u32 m0, s6, 139264
    s_nop 0
    buffer_load_dwordx4 v7, s[40:43], s48 offen sc1 lds
    v_rcp_f32 v240, v240
    v_rcp_f32 v241, v241
    v_rcp_f32 v242, v242
    v_rcp_f32 v243, v243
    s_setprio 0
    v_mul_f32 v176, v176, v240
    v_mul_f32 v177, v177, v241
    v_mul_f32 v178, v178, v242
    v_mul_f32 v179, v179, v243
    v_mul_f32 v244, v250, v180
    v_mul_f32 v245, v250, v181
    v_mul_f32 v246, v250, v182
    v_mul_f32 v247, v250, v183
    s_setprio 1
    v_cvt_pk_bf16_f32 v224, v176, v177
    v_cvt_pk_bf16_f32 v225, v178, v179
    v_exp_f32 v244, v244
    v_exp_f32 v245, v245
    v_exp_f32 v246, v246
    v_exp_f32 v247, v247
    s_setprio 0
    v_mul_f32 v180, v180, v196
    v_mul_f32 v181, v181, v197
    v_mul_f32 v182, v182, v198
    v_mul_f32 v183, v183, v199
    v_fma_f32 v244, v244, v251, v248
    v_fma_f32 v245, v245, v251, v248
    v_fma_f32 v246, v246, v251, v248
    v_fma_f32 v247, v247, v251, v248
    s_setprio 1
    s_add_u32 m0, s6, 147456
    s_nop 0
    buffer_load_dwordx4 v7, s[40:43], s49 offen sc1 lds
    v_rcp_f32 v244, v244
    v_rcp_f32 v245, v245
    v_rcp_f32 v246, v246
    v_rcp_f32 v247, v247
    s_setprio 0
    v_mul_f32 v180, v180, v244
    v_mul_f32 v181, v181, v245
    v_mul_f32 v182, v182, v246
    v_mul_f32 v183, v183, v247
    v_mul_f32 v240, v250, v184
    v_mul_f32 v241, v250, v185
    v_mul_f32 v242, v250, v186
    v_mul_f32 v243, v250, v187
    s_setprio 1
    v_cvt_pk_bf16_f32 v226, v180, v181
    v_cvt_pk_bf16_f32 v227, v182, v183
    buffer_store_dwordx4 v[224:227], v2, s[40:43], s82 offen sc1
    v_exp_f32 v240, v240
    v_exp_f32 v241, v241
    v_exp_f32 v242, v242
    v_exp_f32 v243, v243
    s_setprio 0
    v_mul_f32 v184, v184, v200
    v_mul_f32 v185, v185, v201
    v_mul_f32 v186, v186, v202
    v_mul_f32 v187, v187, v203
    v_fma_f32 v240, v240, v251, v248
    v_fma_f32 v241, v241, v251, v248
    v_fma_f32 v242, v242, v251, v248
    v_fma_f32 v243, v243, v251, v248
    s_setprio 1
    s_add_u32 m0, s6, 155648
    s_nop 0
    buffer_load_dwordx4 v7, s[40:43], s50 offen sc1 lds
    v_rcp_f32 v240, v240
    v_rcp_f32 v241, v241
    v_rcp_f32 v242, v242
    v_rcp_f32 v243, v243
    s_setprio 0
    v_mul_f32 v184, v184, v240
    v_mul_f32 v185, v185, v241
    v_mul_f32 v186, v186, v242
    v_mul_f32 v187, v187, v243
    v_mul_f32 v244, v250, v188
    v_mul_f32 v245, v250, v189
    v_mul_f32 v246, v250, v190
    v_mul_f32 v247, v250, v191
    s_setprio 1
    v_cvt_pk_bf16_f32 v232, v184, v185
    v_cvt_pk_bf16_f32 v233, v186, v187
    v_exp_f32 v244, v244
    v_exp_f32 v245, v245
    v_exp_f32 v246, v246
    v_exp_f32 v247, v247
    s_setprio 0
    v_mul_f32 v188, v188, v204
    v_mul_f32 v189, v189, v205
    v_mul_f32 v190, v190, v206
    v_mul_f32 v191, v191, v207
    v_fma_f32 v244, v244, v251, v248
    v_fma_f32 v245, v245, v251, v248
    v_fma_f32 v246, v246, v251, v248
    v_fma_f32 v247, v247, v251, v248
    s_setprio 1
    v_rcp_f32 v244, v244
    v_rcp_f32 v245, v245
    v_rcp_f32 v246, v246
    v_rcp_f32 v247, v247
    s_setprio 0
    v_mul_f32 v188, v188, v244
    v_mul_f32 v189, v189, v245
    v_mul_f32 v190, v190, v246
    v_mul_f32 v191, v191, v247
    s_setprio 1
    v_cvt_pk_bf16_f32 v234, v188, v189
    v_cvt_pk_bf16_f32 v235, v190, v191
    buffer_store_dwordx4 v[232:235], v0, s[40:43], s82 offen sc1
    s_setprio 0
    s_waitcnt lgkmcnt(0)
    s_and_b32 s73, s73, 0xffff
    s_mov_b32 s74, 1835008
    s_mov_b32 s75, 0x20000
    buffer_load_dword v18, v4, s[40:43], 0 offen sc1
    v_lshrrev_b32 v240, 5, v1
    v_bfe_u32 v241, v1, 2, 2
    v_lshl_add_u32 v242, v240, 2, v241
    s_lshl_b32 s94, s14, 4
    v_add_u32 v242, s94, v242
    v_lshlrev_b32 v242, 7, v242
    v_lshrrev_b32 v241, 1, v241
    v_lshl_add_u32 v242, v241, 6, v242
    v_bfe_u32 v241, v1, 4, 1
    v_lshl_add_u32 v242, v241, 5, v242
    v_and_b32 v241, 3, v1
    s_lshl_b32 s94, s14, 5
    v_lshl_add_u32 v242, v241, 3, v242
    v_xor_b32 v224, s94, v242
    v_xor_b32 v225, 64, v224
    v_add_u32 v226, 0x10000, v224
    v_add_u32 v227, 0x10000, v225
    v_add_u32 v228, 0x20000, v224
    v_add_u32 v229, 0x20000, v225
    v_add_u32 v244, s6, v2
    v_add_u32 v245, 0x10000, v244
    v_add_u32 v246, 0x20000, v244
    s_waitcnt vmcnt(6)
    s_barrier
    s_setprio 1
    ds_read_b128 v[208:211], v9 offset:0
    ds_read_b128 v[212:215], v9 offset:16384
    ds_read_b128 v[216:219], v10 offset:0
    s_mov_b32 s32, s89
    s_waitcnt lgkmcnt(2)
    v_mfma_f32_16x16x32_bf16 v[132:135], v[208:211], v[252:255], v[132:135]
    ds_read_b128 v[220:223], v9 offset:2048
    s_waitcnt lgkmcnt(2)
    v_mfma_f32_16x16x32_bf16 v[128:131], v[212:215], v[252:255], v[128:131]
    ds_read_b128 v[208:211], v10 offset:2048
    s_waitcnt lgkmcnt(2)
    v_mfma_f32_16x16x32_bf16 v[136:139], v[216:219], v[252:255], 0
    ds_read_b128 v[212:215], v9 offset:4096
    s_add_u32 m0, s6, 106496
    s_add_u32 s89, s89, 57344
    buffer_load_dwordx4 v6, s[64:67], s89 offen lds
    s_waitcnt lgkmcnt(2)
    v_mfma_f32_16x16x32_bf16 v[140:143], v[220:223], v[252:255], 0
    ds_read_b128 v[216:219], v10 offset:4096
    v_max_f32 v132, v132, v128
    v_max_f32 v133, v133, v129
    v_max_f32 v134, v134, v130
    v_max_f32 v135, v135, v131
    v_max3_f32 v204, v132, v133, v134
    s_waitcnt lgkmcnt(2)
    v_mfma_f32_16x16x32_bf16 v[144:147], v[208:211], v[252:255], 0
    ds_read_b128 v[220:223], v9 offset:6144
    v_max3_f32 v205, v135, v136, v137
    v_max3_f32 v204, v138, v139, v204
    s_waitcnt lgkmcnt(2)
    v_mfma_f32_16x16x32_bf16 v[148:151], v[212:215], v[252:255], 0
    ds_read_b128 v[208:211], v10 offset:6144
    v_max3_f32 v205, v140, v141, v205
    v_max3_f32 v204, v142, v143, v204
    s_waitcnt lgkmcnt(2)
    v_mfma_f32_16x16x32_bf16 v[152:155], v[216:219], v[252:255], 0
    ds_read_b128 v[212:215], v9 offset:8192
    v_max3_f32 v205, v144, v145, v205
    v_max3_f32 v204, v146, v147, v204
    s_add_u32 m0, s6, 32768
    s_add_u32 s89, s89, 57344
    buffer_load_dwordx4 v6, s[64:67], s89 offen lds
    s_waitcnt lgkmcnt(2)
    v_mfma_f32_16x16x32_bf16 v[156:159], v[220:223], v[252:255], 0
    ds_read_b128 v[216:219], v10 offset:8192
    v_max3_f32 v205, v148, v149, v205
    v_max3_f32 v204, v150, v151, v204
    s_waitcnt lgkmcnt(2)
    v_mfma_f32_16x16x32_bf16 v[160:163], v[208:211], v[252:255], 0
    ds_read_b128 v[220:223], v9 offset:10240
    v_max3_f32 v205, v152, v153, v205
    v_max3_f32 v204, v154, v155, v204
    s_waitcnt lgkmcnt(2)
    v_mfma_f32_16x16x32_bf16 v[164:167], v[212:215], v[252:255], 0
    ds_read_b128 v[208:211], v10 offset:10240
    v_max3_f32 v205, v156, v157, v205
    v_max3_f32 v204, v158, v159, v204
    s_waitcnt lgkmcnt(2)
    v_mfma_f32_16x16x32_bf16 v[168:171], v[216:219], v[252:255], 0
    ds_read_b128 v[212:215], v9 offset:12288
    v_max3_f32 v205, v160, v161, v205
    v_max3_f32 v204, v162, v163, v204
    s_waitcnt lgkmcnt(2)
    v_mfma_f32_16x16x32_bf16 v[172:175], v[220:223], v[252:255], 0
    ds_read_b128 v[216:219], v10 offset:12288
    v_max3_f32 v205, v164, v165, v205
    v_max3_f32 v204, v166, v167, v204
    s_add_u32 s97, s32, 516096
    buffer_load_dwordx4 v[124:127], v6, s[64:67], s97 offen
    s_waitcnt lgkmcnt(2)
    v_mfma_f32_16x16x32_bf16 v[176:179], v[208:211], v[252:255], 0
    ds_read_b128 v[220:223], v9 offset:14336
    v_max3_f32 v205, v168, v169, v205
    v_max3_f32 v204, v170, v171, v204
    s_waitcnt lgkmcnt(2)
    v_mfma_f32_16x16x32_bf16 v[180:183], v[212:215], v[252:255], 0
    ds_read_b128 v[208:211], v10 offset:14336
    v_max3_f32 v205, v172, v173, v205
    v_max3_f32 v204, v174, v175, v204
    s_waitcnt lgkmcnt(2)
    v_mfma_f32_16x16x32_bf16 v[184:187], v[216:219], v[252:255], 0
    v_max3_f32 v205, v176, v177, v205
    v_max3_f32 v204, v178, v179, v204
    s_waitcnt lgkmcnt(1)
    v_mfma_f32_16x16x32_bf16 v[188:191], v[220:223], v[252:255], 0
    v_max3_f32 v205, v180, v181, v205
    v_max3_f32 v204, v182, v183, v204
    s_waitcnt lgkmcnt(0)
    v_mfma_f32_16x16x32_bf16 v[192:195], v[208:211], v[252:255], 0
    v_max3_f32 v205, v184, v185, v205
    v_max3_f32 v204, v186, v187, v204
    s_waitcnt vmcnt(3)
    v_cmp_ne_u32 vcc, s7, v18
    s_nop 0
    s_cmp_lg_u64 vcc, 0
    s_cbranch_scc1 L_spin_18
L_back_19:
    s_or_b32 s97, s2, s3
    s_cmp_lg_u32 s97, 0
    s_cbranch_scc1 L_epoch_20
    v_mov_b32 v18, s7
    s_mov_b32 s97, 32768
    s_mov_b64 exec, 1
    buffer_store_dword v18, off, s[40:43], s97 sc1
    s_mov_b64 exec, -1
L_epoch_20:
    v_max3_f32 v205, v188, v189, v205
    buffer_load_dwordx4 v[16:19], v2, s[40:43], s53 offen offset:0 sc1
    v_max3_f32 v204, v190, v191, v204
    v_max3_f32 v205, v192, v193, v205
    buffer_load_dwordx4 v[20:23], v2, s[40:43], s53 offen offset:1024 sc1
    v_max3_f32 v204, v194, v195, v204
    s_barrier
    s_cmp_lg_u32 s3, 0
    s_cbranch_scc1 L_sig_17
    v_mov_b32 v207, s7
    s_mov_b64 exec, 1
    s_add_u32 s97, s83, 8192
    buffer_store_dword v207, off, s[40:43], s97 sc1
    s_mov_b64 exec, -1
L_sig_17:
    ds_read_b64_tr_b16 v[208:209], v11 offset:0
    ds_read_b64_tr_b16 v[210:211], v12 offset:0
    ds_read_b64_tr_b16 v[212:213], v11 offset:1024
    ds_read_b64_tr_b16 v[214:215], v12 offset:1024
    ds_read_b64_tr_b16 v[216:217], v11 offset:16384
    v_max_f32 v204, v204, v205
    v_mov_b32 v205, v204
    s_nop 1
    v_permlane32_swap_b32 v204, v205
    v_max_f32 v204, v204, v205
    v_mov_b32 v205, v204
    s_nop 1
    v_permlane16_swap_b32 v204, v205
    v_max_f32 v204, v204, v205
    s_mov_b32 s94, 1049335798
    v_mul_f32 v204, -v204, s94
    v_fma_f32 v132, v132, s94, v204
    v_fma_f32 v133, v133, s94, v204
    v_fma_f32 v134, v134, s94, v204
    buffer_load_dwordx4 v[24:27], v2, s[40:43], s53 offen offset:2048 sc1
    v_fma_f32 v135, v135, s94, v204
    v_fma_f32 v136, v136, s94, v204
    v_fma_f32 v137, v137, s94, v204
    v_fma_f32 v138, v138, s94, v204
    v_fma_f32 v139, v139, s94, v204
    v_exp_f32 v132, v132
    v_exp_f32 v133, v133
    buffer_load_dwordx4 v[28:31], v2, s[40:43], s53 offen offset:3072 sc1
    v_exp_f32 v134, v134
    v_exp_f32 v135, v135
    v_exp_f32 v136, v136
    v_exp_f32 v137, v137
    v_exp_f32 v138, v138
    v_exp_f32 v139, v139
    v_cvt_pk_bf16_f32 v132, v132, v133
    s_add_u32 s53, s53, 4096
    buffer_load_dwordx4 v[32:35], v2, s[40:43], s53 offen offset:0 sc1
    v_cvt_pk_bf16_f32 v133, v134, v135
    v_cvt_pk_bf16_f32 v134, v136, v137
    v_cvt_pk_bf16_f32 v135, v138, v139
    v_bfi_b32 v128, v60, 0, v132
    v_bfi_b32 v129, v61, 0, v133
    v_and_b32 v132, v60, v132
    v_and_b32 v133, v61, v133
    v_fma_f32 v140, v140, s94, v204
    v_fma_f32 v141, v141, s94, v204
    v_fma_f32 v142, v142, s94, v204
    s_waitcnt lgkmcnt(3)
    v_mfma_f32_16x16x32_bf16 v[196:199], v[208:211], v[132:135], 0
    ds_read_b64_tr_b16 v[220:221], v11 offset:17408
    v_fma_f32 v143, v143, s94, v204
    v_fma_f32 v144, v144, s94, v204
    v_fma_f32 v145, v145, s94, v204
    s_waitcnt lgkmcnt(2)
    v_mfma_f32_16x16x32_bf16 v[200:203], v[212:215], v[132:135], 0
    ds_read_b64_tr_b16 v[208:209], v11 offset:2048
    ds_read_b64_tr_b16 v[210:211], v12 offset:2048
    v_fma_f32 v146, v146, s94, v204
    v_fma_f32 v147, v147, s94, v204
    v_exp_f32 v140, v140
    s_waitcnt lgkmcnt(3)
    v_mfma_f32_16x16x16_bf16 v[196:199], v[216:217], v[128:129], v[196:199]
    ds_read_b64_tr_b16 v[212:213], v11 offset:3072
    ds_read_b64_tr_b16 v[214:215], v12 offset:3072
    v_exp_f32 v141, v141
    v_exp_f32 v142, v142
    v_exp_f32 v143, v143
    s_waitcnt lgkmcnt(4)
    v_mfma_f32_16x16x16_bf16 v[200:203], v[220:221], v[128:129], v[200:203]
    ds_read_b64_tr_b16 v[216:217], v11 offset:4096
    ds_read_b64_tr_b16 v[218:219], v12 offset:4096
    v_exp_f32 v144, v144
    v_exp_f32 v145, v145
    v_exp_f32 v146, v146
    buffer_load_dwordx4 v[36:39], v2, s[40:43], s53 offen offset:1024 sc1
    v_exp_f32 v147, v147
    v_cvt_pk_bf16_f32 v140, v140, v141
    v_cvt_pk_bf16_f32 v141, v142, v143
    buffer_load_dwordx4 v[40:43], v2, s[40:43], s53 offen offset:2048 sc1
    v_cvt_pk_bf16_f32 v142, v144, v145
    v_cvt_pk_bf16_f32 v143, v146, v147
    v_fma_f32 v148, v148, s94, v204
    v_fma_f32 v149, v149, s94, v204
    v_fma_f32 v150, v150, s94, v204
    s_waitcnt lgkmcnt(4)
    v_mfma_f32_16x16x32_bf16 v[196:199], v[208:211], v[140:143], v[196:199]
    ds_read_b64_tr_b16 v[220:221], v11 offset:5120
    ds_read_b64_tr_b16 v[222:223], v12 offset:5120
    v_fma_f32 v151, v151, s94, v204
    v_fma_f32 v152, v152, s94, v204
    v_fma_f32 v153, v153, s94, v204
    v_fma_f32 v154, v154, s94, v204
    s_waitcnt lgkmcnt(4)
    v_mfma_f32_16x16x32_bf16 v[200:203], v[212:215], v[140:143], v[200:203]
    ds_read_b64_tr_b16 v[208:209], v11 offset:6144
    ds_read_b64_tr_b16 v[210:211], v12 offset:6144
    v_fma_f32 v155, v155, s94, v204
    v_exp_f32 v148, v148
    v_exp_f32 v149, v149
    v_exp_f32 v150, v150
    v_exp_f32 v151, v151
    buffer_load_dwordx4 v[44:47], v2, s[40:43], s53 offen offset:3072 sc1
    v_exp_f32 v152, v152
    v_exp_f32 v153, v153
    v_exp_f32 v154, v154
    v_exp_f32 v155, v155
    s_add_u32 s53, s53, 4096
    buffer_load_dwordx4 v[48:51], v2, s[40:43], s53 offen offset:0 sc1
    v_cvt_pk_bf16_f32 v148, v148, v149
    v_cvt_pk_bf16_f32 v149, v150, v151
    v_cvt_pk_bf16_f32 v150, v152, v153
    v_cvt_pk_bf16_f32 v151, v154, v155
    v_fma_f32 v156, v156, s94, v204
    v_fma_f32 v157, v157, s94, v204
    v_fma_f32 v158, v158, s94, v204
    s_waitcnt lgkmcnt(4)
    v_mfma_f32_16x16x32_bf16 v[196:199], v[216:219], v[148:151], v[196:199]
    ds_read_b64_tr_b16 v[212:213], v11 offset:7168
    ds_read_b64_tr_b16 v[214:215], v12 offset:7168
    v_fma_f32 v159, v159, s94, v204
    v_fma_f32 v160, v160, s94, v204
    v_fma_f32 v161, v161, s94, v204
    v_fma_f32 v162, v162, s94, v204
    s_waitcnt lgkmcnt(4)
    v_mfma_f32_16x16x32_bf16 v[200:203], v[220:223], v[148:151], v[200:203]
    ds_read_b64_tr_b16 v[216:217], v11 offset:8192
    ds_read_b64_tr_b16 v[218:219], v12 offset:8192
    v_fma_f32 v163, v163, s94, v204
    v_exp_f32 v156, v156
    v_exp_f32 v157, v157
    v_exp_f32 v158, v158
    v_exp_f32 v159, v159
    buffer_load_dwordx4 v[52:55], v2, s[40:43], s53 offen offset:1024 sc1
    v_exp_f32 v160, v160
    v_exp_f32 v161, v161
    v_exp_f32 v162, v162
    v_exp_f32 v163, v163
    buffer_load_dwordx4 v[56:59], v2, s[40:43], s53 offen offset:2048 sc1
    v_cvt_pk_bf16_f32 v156, v156, v157
    v_cvt_pk_bf16_f32 v157, v158, v159
    v_cvt_pk_bf16_f32 v158, v160, v161
    v_cvt_pk_bf16_f32 v159, v162, v163
    v_fma_f32 v164, v164, s94, v204
    v_fma_f32 v165, v165, s94, v204
    v_fma_f32 v166, v166, s94, v204
    s_waitcnt lgkmcnt(4)
    v_mfma_f32_16x16x32_bf16 v[196:199], v[208:211], v[156:159], v[196:199]
    ds_read_b64_tr_b16 v[220:221], v11 offset:9216
    ds_read_b64_tr_b16 v[222:223], v12 offset:9216
    v_fma_f32 v167, v167, s94, v204
    v_fma_f32 v168, v168, s94, v204
    v_fma_f32 v169, v169, s94, v204
    v_fma_f32 v170, v170, s94, v204
    s_waitcnt lgkmcnt(4)
    v_mfma_f32_16x16x32_bf16 v[200:203], v[212:215], v[156:159], v[200:203]
    ds_read_b64_tr_b16 v[208:209], v11 offset:10240
    ds_read_b64_tr_b16 v[210:211], v12 offset:10240
    v_fma_f32 v171, v171, s94, v204
    v_exp_f32 v164, v164
    v_exp_f32 v165, v165
    v_exp_f32 v166, v166
    v_exp_f32 v167, v167
    buffer_load_dwordx4 v[60:63], v2, s[40:43], s53 offen offset:3072 sc1
    v_exp_f32 v168, v168
    v_exp_f32 v169, v169
    v_exp_f32 v170, v170
    v_exp_f32 v171, v171
    s_add_u32 m0, s6, 114688
    s_add_u32 s89, s89, 57344
    buffer_load_dwordx4 v6, s[64:67], s89 offen lds
    v_cvt_pk_bf16_f32 v164, v164, v165
    v_cvt_pk_bf16_f32 v165, v166, v167
    v_cvt_pk_bf16_f32 v166, v168, v169
    v_cvt_pk_bf16_f32 v167, v170, v171
    v_fma_f32 v172, v172, s94, v204
    v_fma_f32 v173, v173, s94, v204
    v_fma_f32 v174, v174, s94, v204
    s_waitcnt lgkmcnt(4)
    v_mfma_f32_16x16x32_bf16 v[196:199], v[216:219], v[164:167], v[196:199]
    ds_read_b64_tr_b16 v[212:213], v11 offset:11264
    ds_read_b64_tr_b16 v[214:215], v12 offset:11264
    v_fma_f32 v175, v175, s94, v204
    v_fma_f32 v176, v176, s94, v204
    v_fma_f32 v177, v177, s94, v204
    v_fma_f32 v178, v178, s94, v204
    s_waitcnt lgkmcnt(4)
    v_mfma_f32_16x16x32_bf16 v[200:203], v[220:223], v[164:167], v[200:203]
    ds_read_b64_tr_b16 v[216:217], v11 offset:12288
    ds_read_b64_tr_b16 v[218:219], v12 offset:12288
    v_fma_f32 v179, v179, s94, v204
    v_exp_f32 v172, v172
    v_exp_f32 v173, v173
    v_exp_f32 v174, v174
    v_exp_f32 v175, v175
    s_add_u32 m0, s6, 122880
    s_add_u32 s89, s89, 57344
    buffer_load_dwordx4 v6, s[64:67], s89 offen lds
    v_exp_f32 v176, v176
    v_exp_f32 v177, v177
    v_exp_f32 v178, v178
    v_exp_f32 v179, v179
    s_add_u32 m0, s6, 131072
    s_add_u32 s89, s89, 57344
    buffer_load_dwordx4 v6, s[64:67], s89 offen lds
    v_cvt_pk_bf16_f32 v172, v172, v173
    v_cvt_pk_bf16_f32 v173, v174, v175
    v_cvt_pk_bf16_f32 v174, v176, v177
    v_cvt_pk_bf16_f32 v175, v178, v179
    v_fma_f32 v180, v180, s94, v204
    v_fma_f32 v181, v181, s94, v204
    v_fma_f32 v182, v182, s94, v204
    s_waitcnt lgkmcnt(4)
    v_mfma_f32_16x16x32_bf16 v[196:199], v[208:211], v[172:175], v[196:199]
    ds_read_b64_tr_b16 v[220:221], v11 offset:13312
    ds_read_b64_tr_b16 v[222:223], v12 offset:13312
    v_fma_f32 v183, v183, s94, v204
    v_fma_f32 v184, v184, s94, v204
    v_fma_f32 v185, v185, s94, v204
    v_fma_f32 v186, v186, s94, v204
    v_fma_f32 v187, v187, s94, v204
    v_exp_f32 v180, v180
    s_waitcnt lgkmcnt(4)
    v_mfma_f32_16x16x32_bf16 v[200:203], v[212:215], v[172:175], v[200:203]
    ds_read_b64_tr_b16 v[208:209], v11 offset:14336
    ds_read_b64_tr_b16 v[210:211], v12 offset:14336
    v_exp_f32 v181, v181
    v_exp_f32 v182, v182
    v_exp_f32 v183, v183
    v_exp_f32 v184, v184
    v_exp_f32 v185, v185
    v_exp_f32 v186, v186
    s_cmp_lt_u32 s3, 4
    s_cbranch_scc1 L_hbp_23
    buffer_load_dword v206, v4, s[40:43], s100 offen sc1
L_hbp_23:
    v_exp_f32 v187, v187
    v_cvt_pk_bf16_f32 v180, v180, v181
    v_cvt_pk_bf16_f32 v181, v182, v183
    v_cvt_pk_bf16_f32 v182, v184, v185
    v_cvt_pk_bf16_f32 v183, v186, v187
    v_fma_f32 v188, v188, s94, v204
    v_fma_f32 v189, v189, s94, v204
    v_fma_f32 v190, v190, s94, v204
    s_waitcnt lgkmcnt(4)
    v_mfma_f32_16x16x32_bf16 v[196:199], v[216:219], v[180:183], v[196:199]
    ds_read_b64_tr_b16 v[212:213], v11 offset:15360
    ds_read_b64_tr_b16 v[214:215], v12 offset:15360
    v_fma_f32 v191, v191, s94, v204
    v_fma_f32 v192, v192, s94, v204
    v_fma_f32 v193, v193, s94, v204
    v_fma_f32 v194, v194, s94, v204
    v_fma_f32 v195, v195, s94, v204
    v_exp_f32 v188, v188
    v_exp_f32 v189, v189
    v_exp_f32 v190, v190
    v_exp_f32 v191, v191
    s_waitcnt lgkmcnt(4)
    v_mfma_f32_16x16x32_bf16 v[200:203], v[220:223], v[180:183], v[200:203]
    v_exp_f32 v192, v192
    v_exp_f32 v193, v193
    v_exp_f32 v194, v194
    v_exp_f32 v195, v195
    v_cvt_pk_bf16_f32 v188, v188, v189
    v_cvt_pk_bf16_f32 v189, v190, v191
    v_cvt_pk_bf16_f32 v190, v192, v193
    v_cvt_pk_bf16_f32 v191, v194, v195
    s_waitcnt lgkmcnt(2)
    s_nop 0
    v_mfma_f32_16x16x32_bf16 v[196:199], v[208:211], v[188:191], v[196:199]
    s_waitcnt lgkmcnt(0)
    v_mfma_f32_16x16x32_bf16 v[200:203], v[212:215], v[188:191], v[200:203]
    s_cmp_ge_u32 s3, 4
    s_cbranch_scc1 L_hbp_24
    buffer_load_dword v206, v4, s[40:43], s100 offen sc1
L_hbp_24:
    ds_read_b64_tr_b16 v[216:217], v224 offset:49152
    ds_read_b64_tr_b16 v[218:219], v224 offset:50176
    ds_read_b64_tr_b16 v[208:209], v224 offset:40960
    ds_read_b64_tr_b16 v[210:211], v224 offset:41984
    ds_read_b64_tr_b16 v[212:213], v225 offset:40960
    ds_read_b64_tr_b16 v[214:215], v225 offset:41984
    s_bitcmp0_b32 s92, 0
    s_cbranch_scc1 L_even_25
    v_mov_b32 v204, v196
    v_mov_b32 v205, v196
    s_nop 1
    v_permlane32_swap_b32 v204, v205
    v_mov_b32 v205, v204
    s_nop 1
    v_permlane16_swap_b32 v204, v205
    s_branch L_den_26
L_even_25:
    v_mov_b32 v204, v200
    v_mov_b32 v205, v200
    s_nop 1
    v_permlane32_swap_b32 v205, v204
    v_mov_b32 v205, v204
    s_nop 1
    v_permlane16_swap_b32 v205, v204
L_den_26:
    s_waitcnt vmcnt(15) lgkmcnt(2)
    v_mfma_f32_32x32x16_bf16 v[128:143], v[208:211], v[16:19], 0
    ds_read_b64_tr_b16 v[220:221], v225 offset:49152
    ds_read_b64_tr_b16 v[222:223], v225 offset:50176
    v_rcp_f32 v204, v204
    s_nop 0
    v_mul_f32 v196, v204, v196
    v_mul_f32 v197, v204, v197
    v_mul_f32 v198, v204, v198
    v_mul_f32 v199, v204, v199
    v_mul_f32 v200, v204, v200
    v_mul_f32 v201, v204, v201
    v_mul_f32 v202, v204, v202
    v_mul_f32 v203, v204, v203
    s_waitcnt lgkmcnt(2)
    v_mfma_f32_32x32x16_bf16 v[144:159], v[212:215], v[16:19], 0
    ds_read_b64_tr_b16 v[208:209], v224 offset:57344
    ds_read_b64_tr_b16 v[210:211], v224 offset:58368
    v_cvt_pk_bf16_f32 v196, v196, v197
    v_cvt_pk_bf16_f32 v197, v198, v199
    v_cvt_pk_bf16_f32 v198, v200, v201
    v_cvt_pk_bf16_f32 v199, v202, v203
    s_waitcnt vmcnt(14)
    v_mfma_f32_32x32x16_bf16 v[128:143], v[216:219], v[20:23], v[128:143]
    ds_read_b64_tr_b16 v[212:213], v225 offset:57344
    ds_read_b64_tr_b16 v[214:215], v225 offset:58368
    v_permlane16_swap_b32 v196, v198
    v_permlane16_swap_b32 v197, v199
    s_bitcmp1_b32 s92, 0
    s_cbranch_scc1 L_odd_27
    s_mov_b32 exec_hi, 0xffff
    buffer_store_dwordx4 v[196:199], v5, s[40:43], s51 offen offset:0 sc1
    s_not_b64 exec, exec
    buffer_store_dwordx2 v[196:197], v5, s[40:43], s51 offen offset:0 sc1
    s_branch L_ost_28
L_odd_27:
    s_mov_b32 exec_lo, 0xffff0000
    buffer_store_dwordx4 v[196:199], v5, s[40:43], s51 offen offset:0 sc1
    s_not_b64 exec, exec
    buffer_store_dwordx2 v[198:199], v5, s[40:43], s51 offen offset:0 sc1
L_ost_28:
    s_mov_b64 exec, -1
    s_setprio 0
    s_cmp_eq_u32 s101, 7
    s_cbranch_scc1 L_noout
    s_waitcnt vmcnt(2)
    v_cmp_ne_u32 vcc, s7, v206
    s_nop 0
    s_cmp_lg_u64 vcc, 0
    s_cbranch_scc1 L_spin_21
L_back_22:
    s_add_u32 s53, s53, 4096
    buffer_load_dwordx4 v[64:67], v2, s[40:43], s53 offen offset:0 sc1
    buffer_load_dwordx4 v[68:71], v2, s[40:43], s53 offen offset:1024 sc1
    buffer_load_dwordx4 v[72:75], v2, s[40:43], s53 offen offset:2048 sc1
    s_waitcnt lgkmcnt(4)
    v_mfma_f32_32x32x16_bf16 v[144:159], v[220:223], v[20:23], v[144:159]
    ds_read_b64_tr_b16 v[216:217], v224 offset:0
    ds_read_b64_tr_b16 v[218:219], v224 offset:1024
    buffer_load_dwordx4 v[76:79], v2, s[40:43], s53 offen offset:3072 sc1
    s_add_u32 s53, s53, 4096
    buffer_load_dwordx4 v[80:83], v2, s[40:43], s53 offen offset:0 sc1
    buffer_load_dwordx4 v[84:87], v2, s[40:43], s53 offen offset:1024 sc1
    s_waitcnt lgkmcnt(4)
    v_mfma_f32_32x32x16_bf16 v[128:143], v[208:211], v[24:27], v[128:143]
    ds_read_b64_tr_b16 v[220:221], v225 offset:0
    ds_read_b64_tr_b16 v[222:223], v225 offset:1024
    buffer_load_dwordx4 v[88:91], v2, s[40:43], s53 offen offset:2048 sc1
    buffer_load_dwordx4 v[92:95], v2, s[40:43], s53 offen offset:3072 sc1
    s_waitcnt lgkmcnt(4)
    v_mfma_f32_32x32x16_bf16 v[144:159], v[212:215], v[24:27], v[144:159]
    s_barrier
    ds_read_b64_tr_b16 v[208:209], v224 offset:8192
    ds_read_b64_tr_b16 v[210:211], v224 offset:9216
    ds_write_b128 v246, v[112:115] offset:8192
    ds_write_b128 v246, v[116:119] offset:16384
    s_waitcnt lgkmcnt(6)
    v_mfma_f32_32x32x16_bf16 v[128:143], v[216:219], v[28:31], v[128:143]
    ds_read_b64_tr_b16 v[212:213], v225 offset:8192
    ds_read_b64_tr_b16 v[214:215], v225 offset:9216
    ds_write_b128 v246, v[120:123] offset:24576
    ds_write_b128 v244, v[124:127] offset:40960
    s_waitcnt lgkmcnt(8)
    v_mfma_f32_32x32x16_bf16 v[144:159], v[220:223], v[28:31], v[144:159]
    ds_read_b64_tr_b16 v[216:217], v226 offset:0
    ds_read_b64_tr_b16 v[218:219], v226 offset:1024
    s_add_u32 s53, s53, 4096
    buffer_load_dwordx4 v[96:99], v2, s[40:43], s53 offen offset:0 sc1
    s_waitcnt lgkmcnt(8)
    v_mfma_f32_32x32x16_bf16 v[128:143], v[208:211], v[32:35], v[128:143]
    ds_read_b64_tr_b16 v[220:221], v227 offset:0
    ds_read_b64_tr_b16 v[222:223], v227 offset:1024
    buffer_load_dwordx4 v[100:103], v2, s[40:43], s53 offen offset:1024 sc1
    s_waitcnt lgkmcnt(6)
    v_mfma_f32_32x32x16_bf16 v[144:159], v[212:215], v[32:35], v[144:159]
    ds_read_b64_tr_b16 v[208:209], v226 offset:8192
    ds_read_b64_tr_b16 v[210:211], v226 offset:9216
    buffer_load_dwordx4 v[104:107], v2, s[40:43], s53 offen offset:2048 sc1
    s_waitcnt lgkmcnt(4)
    v_mfma_f32_32x32x16_bf16 v[128:143], v[216:219], v[36:39], v[128:143]
    ds_read_b64_tr_b16 v[212:213], v227 offset:8192
    ds_read_b64_tr_b16 v[214:215], v227 offset:9216
    buffer_load_dwordx4 v[108:111], v2, s[40:43], s53 offen offset:3072 sc1
    s_waitcnt lgkmcnt(4)
    v_mfma_f32_32x32x16_bf16 v[144:159], v[220:223], v[36:39], v[144:159]
    ds_read_b64_tr_b16 v[216:217], v226 offset:16384
    ds_read_b64_tr_b16 v[218:219], v226 offset:17408
    s_add_u32 m0, s6, 49152
    s_add_u32 s89, s89, 286720
    buffer_load_dwordx4 v6, s[64:67], s89 offen lds
    s_waitcnt lgkmcnt(4)
    v_mfma_f32_32x32x16_bf16 v[128:143], v[208:211], v[40:43], v[128:143]
    ds_read_b64_tr_b16 v[220:221], v227 offset:16384
    ds_read_b64_tr_b16 v[222:223], v227 offset:17408
    s_waitcnt lgkmcnt(4)
    v_mfma_f32_32x32x16_bf16 v[144:159], v[212:215], v[40:43], v[144:159]
    s_waitcnt vmcnt(13)
    s_barrier
    ds_read_b64_tr_b16 v[208:209], v224 offset:16384
    ds_read_b64_tr_b16 v[210:211], v224 offset:17408
    s_cmp_lg_u32 s3, 0
    s_cbranch_scc1 L_sig_29
    v_mov_b32 v192, s7
    s_mov_b64 exec, 1
    buffer_store_dword v192, off, s[40:43], s52 sc1
    s_mov_b64 exec, -1
L_sig_29:
    s_waitcnt lgkmcnt(4)
    v_mfma_f32_32x32x16_bf16 v[128:143], v[216:219], v[44:47], v[128:143]
    ds_read_b64_tr_b16 v[212:213], v225 offset:16384
    ds_read_b64_tr_b16 v[214:215], v225 offset:17408
    s_lshl_b32 s94, s3, 11
    v_add_u32 v230, s94, v2
    s_add_u32 s53, s53, 4096
    buffer_load_dwordx4 v[112:115], v2, s[40:43], s53 offen offset:0 sc1
    s_waitcnt lgkmcnt(4)
    v_mfma_f32_32x32x16_bf16 v[144:159], v[220:223], v[44:47], v[144:159]
    ds_read_b64_tr_b16 v[216:217], v224 offset:24576
    ds_read_b64_tr_b16 v[218:219], v224 offset:25600
    v_add_u32 v231, 0x20000, v230
    v_xor_b32 v235, 6144, v230
    buffer_load_dwordx4 v[116:119], v2, s[40:43], s53 offen offset:1024 sc1
    s_waitcnt lgkmcnt(4)
    v_mfma_f32_32x32x16_bf16 v[128:143], v[208:211], v[48:51], v[128:143]
    ds_read_b64_tr_b16 v[220:221], v225 offset:24576
    ds_read_b64_tr_b16 v[222:223], v225 offset:25600
    v_xor_b32 v232, 2048, v231
    v_xor_b32 v233, 0x1000, v231
    s_add_u32 m0, s6, 57344
    s_add_u32 s89, s89, 57344
    buffer_load_dwordx4 v6, s[64:67], s89 offen lds
    s_waitcnt lgkmcnt(4)
    v_mfma_f32_32x32x16_bf16 v[144:159], v[212:215], v[48:51], v[144:159]
    ds_read_b64_tr_b16 v[208:209], v226 offset:24576
    ds_read_b64_tr_b16 v[210:211], v226 offset:25600
    v_and_b32 v241, 31, v1
    v_mul_u32_u24 v241, 896, v241
    s_waitcnt lgkmcnt(4)
    v_mfma_f32_32x32x16_bf16 v[128:143], v[216:219], v[52:55], v[128:143]
    ds_read_b64_tr_b16 v[212:213], v227 offset:24576
    ds_read_b64_tr_b16 v[214:215], v227 offset:25600
    v_lshl_add_u32 v234, v240, 4, v241
    v_lshlrev_b32 v249, 3, v1
    s_add_u32 m0, s6, 0
    s_add_u32 s89, s89, 57344
    buffer_load_dwordx4 v6, s[64:67], s89 offen lds
    s_waitcnt lgkmcnt(4)
    v_mfma_f32_32x32x16_bf16 v[144:159], v[220:223], v[52:55], v[144:159]
    ds_read_b64_tr_b16 v[216:217], v226 offset:32768
    ds_read_b64_tr_b16 v[218:219], v226 offset:33792
    v_lshl_add_u32 v249, v240, 8, v249
    v_lshl_add_u32 v248, v240, 9, v224
    s_add_u32 m0, s6, 8192
    s_add_u32 s89, s89, 57344
    buffer_load_dwordx4 v6, s[64:67], s89 offen lds
    s_waitcnt lgkmcnt(4)
    v_mfma_f32_32x32x16_bf16 v[128:143], v[208:211], v[56:59], v[128:143]
    ds_read_b64_tr_b16 v[220:221], v227 offset:32768
    ds_read_b64_tr_b16 v[222:223], v227 offset:33792
    s_and_b32 s94, s14, 1
    s_lshl_b32 s94, s94, 1
    s_sub_u32 s94, s94, s14
    s_lshl_b32 s94, s94, 11
    v_add_u32 v248, s94, v248
    v_add_u32 v250, 0x10000, v248
    s_waitcnt lgkmcnt(4)
    v_mfma_f32_32x32x16_bf16 v[144:159], v[212:215], v[56:59], v[144:159]
    s_barrier
    ds_read_b64_tr_b16 v[208:209], v226 offset:40960
    ds_read_b64_tr_b16 v[210:211], v226 offset:41984
    s_waitcnt lgkmcnt(4)
    v_mfma_f32_32x32x16_bf16 v[128:143], v[216:219], v[60:63], v[128:143]
    ds_read_b64_tr_b16 v[212:213], v227 offset:40960
    ds_read_b64_tr_b16 v[214:215], v227 offset:41984
    buffer_load_dwordx4 v[120:123], v2, s[40:43], s53 offen offset:2048 sc1
    s_waitcnt lgkmcnt(4)
    v_mfma_f32_32x32x16_bf16 v[144:159], v[220:223], v[60:63], v[144:159]
    ds_read_b64_tr_b16 v[216:217], v224 offset:32768
    ds_read_b64_tr_b16 v[218:219], v224 offset:33792
    buffer_load_dwordx4 v[124:127], v2, s[40:43], s53 offen offset:3072 sc1
    s_waitcnt vmcnt(19) lgkmcnt(4)
    v_mfma_f32_32x32x16_bf16 v[128:143], v[208:211], v[64:67], v[128:143]
    ds_read_b64_tr_b16 v[220:221], v225 offset:32768
    ds_read_b64_tr_b16 v[222:223], v225 offset:33792
    s_add_u32 m0, s6, 65536
    s_add_u32 s89, s89, 57344
    buffer_load_dwordx4 v6, s[64:67], s89 offen lds
    s_waitcnt lgkmcnt(4)
    v_mfma_f32_32x32x16_bf16 v[144:159], v[212:215], v[64:67], v[144:159]
    ds_read_b64_tr_b16 v[208:209], v226 offset:49152
    ds_read_b64_tr_b16 v[210:211], v226 offset:50176
    s_add_u32 m0, s6, 73728
    s_add_u32 s89, s89, 57344
    buffer_load_dwordx4 v6, s[64:67], s89 offen lds
    s_waitcnt vmcnt(20) lgkmcnt(4)
    v_mfma_f32_32x32x16_bf16 v[128:143], v[216:219], v[68:71], v[128:143]
    ds_read_b64_tr_b16 v[212:213], v227 offset:49152
    ds_read_b64_tr_b16 v[214:215], v227 offset:50176
    s_add_u32 m0, s6, 81920
    s_add_u32 s89, s89, 57344
    buffer_load_dwordx4 v6, s[64:67], s89 offen lds
    s_waitcnt lgkmcnt(4)
    v_mfma_f32_32x32x16_bf16 v[144:159], v[220:223], v[68:71], v[144:159]
    ds_read_b64_tr_b16 v[216:217], v226 offset:57344
    ds_read_b64_tr_b16 v[218:219], v226 offset:58368
    s_add_u32 m0, s6, 16384
    s_nop 0
    buffer_load_dwordx4 v6, s[68:71], s90 offen lds
    s_waitcnt vmcnt(21) lgkmcnt(4)
    v_mfma_f32_32x32x16_bf16 v[128:143], v[208:211], v[72:75], v[128:143]
    ds_read_b64_tr_b16 v[220:221], v227 offset:57344
    ds_read_b64_tr_b16 v[222:223], v227 offset:58368
    s_waitcnt lgkmcnt(4)
    v_mfma_f32_32x32x16_bf16 v[144:159], v[212:215], v[72:75], v[144:159]
    s_barrier
    ds_read_b64_tr_b16 v[208:209], v228 offset:0
    ds_read_b64_tr_b16 v[210:211], v228 offset:1024
    s_movk_i32 s95, 8192
    s_waitcnt vmcnt(20) lgkmcnt(4)
    v_mfma_f32_32x32x16_bf16 v[128:143], v[216:219], v[76:79], v[128:143]
    ds_read_b64_tr_b16 v[212:213], v229 offset:0
    ds_read_b64_tr_b16 v[214:215], v229 offset:1024
    s_add_u32 m0, s6, 24576
    s_add_u32 s90, s90, 7168
    buffer_load_dwordx4 v6, s[68:71], s90 offen lds
    s_waitcnt lgkmcnt(4)
    v_mfma_f32_32x32x16_bf16 v[144:159], v[220:223], v[76:79], v[144:159]
    ds_read_b64_tr_b16 v[216:217], v228 offset:8192
    ds_read_b64_tr_b16 v[218:219], v228 offset:9216
    s_add_u32 m0, s6, 90112
    s_add_u32 s90, s90, 7168
    buffer_load_dwordx4 v6, s[68:71], s90 offen lds
    s_waitcnt vmcnt(21) lgkmcnt(4)
    v_mfma_f32_32x32x16_bf16 v[128:143], v[208:211], v[80:83], v[128:143]
    ds_read_b64_tr_b16 v[220:221], v229 offset:8192
    ds_read_b64_tr_b16 v[222:223], v229 offset:9216
    s_waitcnt lgkmcnt(4)
    v_mfma_f32_32x32x16_bf16 v[144:159], v[212:215], v[80:83], v[144:159]
    ds_read_b64_tr_b16 v[208:209], v228 offset:16384
    ds_read_b64_tr_b16 v[210:211], v228 offset:17408
    s_add_u32 m0, s6, 98304
    s_add_u32 s90, s90, 7168
    buffer_load_dwordx4 v6, s[68:71], s90 offen lds
    s_waitcnt vmcnt(21) lgkmcnt(4)
    v_mfma_f32_32x32x16_bf16 v[128:143], v[216:219], v[84:87], v[128:143]
    ds_read_b64_tr_b16 v[212:213], v229 offset:16384
    ds_read_b64_tr_b16 v[214:215], v229 offset:17408
    s_waitcnt lgkmcnt(4)
    v_mfma_f32_32x32x16_bf16 v[144:159], v[220:223], v[84:87], v[144:159]
    ds_read_b64_tr_b16 v[216:217], v228 offset:24576
    ds_read_b64_tr_b16 v[218:219], v228 offset:25600
    s_add_u32 m0, s6, 106496
    s_add_u32 s90, s90, 7168
    buffer_load_dwordx4 v6, s[68:71], s90 offen lds
    s_waitcnt vmcnt(21) lgkmcnt(4)
    v_mfma_f32_32x32x16_bf16 v[128:143], v[208:211], v[88:91], v[128:143]
    ds_read_b64_tr_b16 v[220:221], v229 offset:24576
    ds_read_b64_tr_b16 v[222:223], v229 offset:25600
    s_waitcnt lgkmcnt(4)
    v_mfma_f32_32x32x16_bf16 v[144:159], v[212:215], v[88:91], v[144:159]
    s_waitcnt vmcnt(11)
    s_barrier
    ds_read_b64_tr_b16 v[208:209], v224 offset:40960
    ds_read_b64_tr_b16 v[210:211], v224 offset:41984
    buffer_load_dword v193, v4, s[40:43], s95 offen sc1
    s_waitcnt lgkmcnt(4)
    v_mfma_f32_32x32x16_bf16 v[128:143], v[216:219], v[92:95], v[128:143]
    ds_read_b64_tr_b16 v[212:213], v225 offset:40960
    ds_read_b64_tr_b16 v[214:215], v225 offset:41984
    s_add_u32 m0, s6, 114688
    s_add_u32 s90, s90, 7168
    buffer_load_dwordx4 v6, s[68:71], s90 offen lds
    s_waitcnt lgkmcnt(4)
    v_mfma_f32_32x32x16_bf16 v[144:159], v[220:223], v[92:95], v[144:159]
    ds_read_b64_tr_b16 v[216:217], v224 offset:49152
    ds_read_b64_tr_b16 v[218:219], v224 offset:50176
    s_waitcnt lgkmcnt(4)
    v_mfma_f32_32x32x16_bf16 v[128:143], v[208:211], v[96:99], v[128:143]
    ds_read_b64_tr_b16 v[220:221], v225 offset:49152
    ds_read_b64_tr_b16 v[222:223], v225 offset:50176
    s_add_u32 m0, s6, 122880
    s_add_u32 s90, s90, 7168
    buffer_load_dwordx4 v6, s[68:71], s90 offen lds
    s_waitcnt lgkmcnt(4)
    v_mfma_f32_32x32x16_bf16 v[144:159], v[212:215], v[96:99], v[144:159]
    ds_read_b64_tr_b16 v[208:209], v224 offset:57344
    ds_read_b64_tr_b16 v[210:211], v224 offset:58368
    s_waitcnt lgkmcnt(4)
    v_mfma_f32_32x32x16_bf16 v[128:143], v[216:219], v[100:103], v[128:143]
    ds_read_b64_tr_b16 v[212:213], v225 offset:57344
    ds_read_b64_tr_b16 v[214:215], v225 offset:58368
    buffer_load_dwordx4 v[236:239], v234, s[36:39], s55 offen
    s_waitcnt lgkmcnt(4)
    v_mfma_f32_32x32x16_bf16 v[144:159], v[220:223], v[100:103], v[144:159]
    ds_read_b64_tr_b16 v[216:217], v224 offset:0
    ds_read_b64_tr_b16 v[218:219], v224 offset:1024
    s_waitcnt lgkmcnt(4)
    v_mfma_f32_32x32x16_bf16 v[128:143], v[208:211], v[104:107], v[128:143]
    ds_read_b64_tr_b16 v[220:221], v225 offset:0
    ds_read_b64_tr_b16 v[222:223], v225 offset:1024
    s_waitcnt lgkmcnt(4)
    v_mfma_f32_32x32x16_bf16 v[144:159], v[212:215], v[104:107], v[144:159]
    s_waitcnt vmcnt(9)
    s_barrier
    ds_read_b64_tr_b16 v[208:209], v225 offset:8192
    ds_read_b64_tr_b16 v[210:211], v225 offset:9216
    s_waitcnt vmcnt(3)
    v_cmp_ne_u32 vcc, s7, v193
    s_nop 0
    s_cmp_lg_u64 vcc, 0
    s_cbranch_scc1 L_spin_30
L_back_31:
    s_waitcnt lgkmcnt(4)
    v_mfma_f32_32x32x16_bf16 v[128:143], v[216:219], v[108:111], v[128:143]
    ds_read_b64_tr_b16 v[212:213], v227 offset:0
    ds_read_b64_tr_b16 v[214:215], v227 offset:1024
    buffer_load_dwordx4 v[16:19], v2, s[40:43], s54 offen offset:0 sc1
    s_waitcnt lgkmcnt(4)
    v_mfma_f32_32x32x16_bf16 v[144:159], v[220:223], v[108:111], v[144:159]
    ds_read_b64_tr_b16 v[216:217], v227 offset:8192
    ds_read_b64_tr_b16 v[218:219], v227 offset:9216
    buffer_load_dwordx4 v[20:23], v2, s[40:43], s54 offen offset:1024 sc1
    s_waitcnt lgkmcnt(4)
    v_mfma_f32_32x32x16_bf16 v[144:159], v[208:211], v[112:115], v[144:159]
    ds_read_b64_tr_b16 v[220:221], v227 offset:16384
    ds_read_b64_tr_b16 v[222:223], v227 offset:17408
    s_waitcnt lgkmcnt(4)
    v_mfma_f32_32x32x16_bf16 v[144:159], v[212:215], v[116:119], v[144:159]
    ds_read_b64_tr_b16 v[208:209], v224 offset:8192
    ds_read_b64_tr_b16 v[210:211], v224 offset:9216
    buffer_load_dwordx4 v[24:27], v2, s[40:43], s54 offen offset:2048 sc1
    s_waitcnt lgkmcnt(4)
    v_mfma_f32_32x32x16_bf16 v[144:159], v[216:219], v[120:123], v[144:159]
    ds_read_b64_tr_b16 v[212:213], v226 offset:0
    ds_read_b64_tr_b16 v[214:215], v226 offset:1024
    s_waitcnt lgkmcnt(4)
    v_mfma_f32_32x32x16_bf16 v[144:159], v[220:223], v[124:127], v[144:159]
    ds_read_b64_tr_b16 v[216:217], v226 offset:8192
    ds_read_b64_tr_b16 v[218:219], v226 offset:9216
    buffer_load_dwordx2 v[28:29], v249, s[40:43], s54 offen offset:3072 sc1
    buffer_load_dwordx2 v[30:31], v249, s[40:43], s54 offen offset:3328 sc1
    s_waitcnt lgkmcnt(4)
    v_mfma_f32_32x32x16_bf16 v[128:143], v[208:211], v[112:115], v[128:143]
    ds_read_b64_tr_b16 v[220:221], v226 offset:16384
    ds_read_b64_tr_b16 v[222:223], v226 offset:17408
    s_nop 3
    ds_write_b128 v231, v[148:151] offset:17408
    ds_write_b128 v231, v[144:147] offset:16384
    s_waitcnt lgkmcnt(6)
    v_mfma_f32_32x32x16_bf16 v[128:143], v[212:215], v[116:119], v[128:143]
    s_waitcnt vmcnt(6)
    s_barrier
    ds_read_b64_tr_b16 v[208:209], v248 offset:16384
    ds_read_b64_tr_b16 v[210:211], v248 offset:16896
    ds_write_b128 v230, v[156:159] offset:50176
    ds_write_b128 v230, v[152:155] offset:49152
    s_waitcnt lgkmcnt(8)
    v_mfma_f32_32x32x16_bf16 v[128:143], v[216:219], v[120:123], v[128:143]
    ds_read_b64_tr_b16 v[212:213], v248 offset:24576
    ds_read_b64_tr_b16 v[214:215], v248 offset:25088
    s_add_u32 s54, s54, 4096
    buffer_load_dwordx4 v[32:35], v2, s[40:43], s54 offen offset:0 sc1
    buffer_load_dwordx4 v[36:39], v2, s[40:43], s54 offen offset:1024 sc1
    s_waitcnt lgkmcnt(8)
    v_mfma_f32_32x32x16_bf16 v[128:143], v[220:223], v[124:127], v[128:143]
    ds_read_b64_tr_b16 v[216:217], v250 offset:24576
    ds_read_b64_tr_b16 v[218:219], v250 offset:25088
    buffer_load_dwordx4 v[40:43], v2, s[40:43], s54 offen offset:2048 sc1
    s_waitcnt vmcnt(7) lgkmcnt(6)
    v_mfma_f32_32x32x16_bf16 v[160:175], v[208:211], v[16:19], 0
    ds_read_b64_tr_b16 v[220:221], v250 offset:32768
    ds_read_b64_tr_b16 v[222:223], v250 offset:33280
    buffer_load_dwordx4 v[44:47], v2, s[40:43], s54 offen offset:3072 sc1
    s_waitcnt vmcnt(7) lgkmcnt(4)
    v_mfma_f32_32x32x16_bf16 v[160:175], v[212:215], v[20:23], v[160:175]
    ds_read_b64_tr_b16 v[208:209], v250 offset:40960
    ds_read_b64_tr_b16 v[210:211], v250 offset:41472
    ds_write_b128 v231, v[136:139] offset:0
    s_add_u32 s54, s54, 4096
    buffer_load_dwordx4 v[48:51], v2, s[40:43], s54 offen offset:0 sc1
    s_waitcnt vmcnt(7) lgkmcnt(5)
    v_mfma_f32_32x32x16_bf16 v[160:175], v[216:219], v[24:27], v[160:175]
    ds_read_b64_tr_b16 v[212:213], v250 offset:49152
    ds_read_b64_tr_b16 v[214:215], v250 offset:49664
    ds_write_b128 v231, v[140:143] offset:1024
    buffer_load_dwordx4 v[52:55], v2, s[40:43], s54 offen offset:1024 sc1
    s_waitcnt vmcnt(6) lgkmcnt(6)
    v_mfma_f32_32x32x16_bf16 v[160:175], v[220:223], v[28:31], v[160:175]
    ds_read_b64_tr_b16 v[216:217], v250 offset:57344
    ds_read_b64_tr_b16 v[218:219], v250 offset:57856
    s_waitcnt lgkmcnt(2)
    s_barrier
    ds_read_b128 v[80:83], v232 offset:0
    ds_read_b128 v[84:87], v232 offset:1024
    ds_read_b128 v[88:91], v233 offset:16384
    ds_read_b128 v[92:95], v233 offset:17408
    ds_read_b128 v[96:99], v235 offset:49152
    ds_read_b128 v[100:103], v235 offset:50176
    v_xor_b32 v224, 2048, v230
    buffer_load_dwordx2 v[56:57], v249, s[40:43], s54 offen offset:2048 sc1
    buffer_load_dwordx2 v[58:59], v249, s[40:43], s54 offen offset:2304 sc1
    s_waitcnt vmcnt(7)
    v_mfma_f32_32x32x16_bf16 v[160:175], v[208:211], v[32:35], v[160:175]
    ds_read_b64_tr_b16 v[220:221], v248 offset:18432
    ds_read_b64_tr_b16 v[222:223], v248 offset:18944
    v_permlane32_swap_b32 v236, v238
    v_permlane32_swap_b32 v237, v239
    v_lshlrev_b32 v192, 16, v236
    v_and_b32 v193, 0xffff0000, v236
    v_lshlrev_b32 v194, 16, v237
    s_waitcnt lgkmcnt(7)
    v_add_f32 v128, v128, v80
    v_add_f32 v129, v129, v81
    v_add_f32 v130, v130, v82
    v_add_f32 v131, v131, v83
    s_waitcnt lgkmcnt(6)
    v_add_f32 v132, v132, v84
    v_add_f32 v133, v133, v85
    v_add_f32 v134, v134, v86
    buffer_load_dwordx4 v[60:63], v2, s[40:43], s54 offen offset:3072 sc1
    s_waitcnt vmcnt(7)
    v_mfma_f32_32x32x16_bf16 v[160:175], v[212:215], v[36:39], v[160:175]
    ds_read_b64_tr_b16 v[208:209], v248 offset:26624
    ds_read_b64_tr_b16 v[210:211], v248 offset:27136
    v_and_b32 v195, 0xffff0000, v237
    v_lshlrev_b32 v196, 16, v238
    v_and_b32 v197, 0xffff0000, v238
    v_lshlrev_b32 v198, 16, v239
    v_and_b32 v199, 0xffff0000, v239
    v_add_f32 v135, v135, v87
    s_waitcnt lgkmcnt(7)
    v_add_f32 v128, v128, v88
    v_add_f32 v129, v129, v89
    v_add_f32 v130, v130, v90
    v_add_f32 v131, v131, v91
    s_waitcnt lgkmcnt(6)
    v_add_f32 v132, v132, v92
    s_add_u32 s54, s54, 4096
    buffer_load_dwordx4 v[64:67], v2, s[40:43], s54 offen offset:0 sc1
    s_waitcnt vmcnt(7)
    v_mfma_f32_32x32x16_bf16 v[160:175], v[216:219], v[40:43], v[160:175]
    ds_read_b64_tr_b16 v[212:213], v250 offset:26624
    ds_read_b64_tr_b16 v[214:215], v250 offset:27136
    v_add_f32 v133, v133, v93
    v_add_f32 v134, v134, v94
    v_add_f32 v135, v135, v95
    s_waitcnt lgkmcnt(7)
    v_add_f32 v128, v128, v96
    v_add_f32 v129, v129, v97
    v_add_f32 v130, v130, v98
    v_add_f32 v131, v131, v99
    buffer_load_dwordx4 v[68:71], v2, s[40:43], s54 offen offset:1024 sc1
    s_waitcnt vmcnt(7) lgkmcnt(4)
    v_mfma_f32_32x32x16_bf16 v[160:175], v[220:223], v[44:47], v[160:175]
    ds_read_b64_tr_b16 v[216:217], v250 offset:34816
    ds_read_b64_tr_b16 v[218:219], v250 offset:35328
    v_add_f32 v132, v132, v100
    v_add_f32 v133, v133, v101
    v_add_f32 v134, v134, v102
    v_add_f32 v135, v135, v103
    v_mul_f32 v240, 0xbfb8aa3b, v128
    v_mul_f32 v241, 0xbfb8aa3b, v129
    s_waitcnt vmcnt(6) lgkmcnt(4)
    v_mfma_f32_32x32x16_bf16 v[160:175], v[208:211], v[48:51], v[160:175]
    ds_read_b64_tr_b16 v[220:221], v250 offset:43008
    ds_read_b64_tr_b16 v[222:223], v250 offset:43520
    v_mul_f32 v242, 0xbfb8aa3b, v130
    v_mul_f32 v243, 0xbfb8aa3b, v131
    v_mul_f32 v244, 0xbfb8aa3b, v132
    v_mul_f32 v245, 0xbfb8aa3b, v133
    v_mul_f32 v246, 0xbfb8aa3b, v134
    v_mul_f32 v247, 0xbfb8aa3b, v135
    s_waitcnt vmcnt(5) lgkmcnt(4)
    v_mfma_f32_32x32x16_bf16 v[160:175], v[212:215], v[52:55], v[160:175]
    ds_read_b64_tr_b16 v[208:209], v250 offset:51200
    ds_read_b64_tr_b16 v[210:211], v250 offset:51712
    v_exp_f32 v240, v240
    v_exp_f32 v241, v241
    v_exp_f32 v242, v242
    v_exp_f32 v243, v243
    v_exp_f32 v244, v244
    v_exp_f32 v245, v245
    v_exp_f32 v246, v246
    s_waitcnt vmcnt(3) lgkmcnt(4)
    v_mfma_f32_32x32x16_bf16 v[160:175], v[216:219], v[56:59], v[160:175]
    ds_read_b64_tr_b16 v[212:213], v250 offset:59392
    ds_read_b64_tr_b16 v[214:215], v250 offset:59904
    v_exp_f32 v247, v247
    v_add_f32 v240, 1.0, v240
    v_add_f32 v241, 1.0, v241
    v_add_f32 v242, 1.0, v242
    v_add_f32 v243, 1.0, v243
    v_add_f32 v244, 1.0, v244
    s_waitcnt vmcnt(2) lgkmcnt(4)
    v_mfma_f32_32x32x16_bf16 v[160:175], v[220:223], v[60:63], v[160:175]
    v_add_f32 v245, 1.0, v245
    v_add_f32 v246, 1.0, v246
    v_add_f32 v247, 1.0, v247
    v_rcp_f32 v240, v240
    v_rcp_f32 v241, v241
    v_rcp_f32 v242, v242
    v_rcp_f32 v243, v243
    s_waitcnt vmcnt(1) lgkmcnt(2)
    v_mfma_f32_32x32x16_bf16 v[160:175], v[208:211], v[64:67], v[160:175]
    v_rcp_f32 v244, v244
    v_rcp_f32 v245, v245
    v_rcp_f32 v246, v246
    v_rcp_f32 v247, v247
    v_mul_f32 v200, v128, v240
    v_mul_f32 v201, v129, v241
    s_waitcnt vmcnt(0) lgkmcnt(0)
    v_mfma_f32_32x32x16_bf16 v[160:175], v[212:215], v[68:71], v[160:175]
    v_mul_f32 v202, v130, v242
    v_mul_f32 v203, v131, v243
    v_mul_f32 v204, v132, v244
    v_mul_f32 v205, v133, v245
    v_mul_f32 v206, v134, v246
    v_mul_f32 v207, v135, v247
    s_nop 5
    ds_write_b128 v230, v[168:171] offset:0
    ds_write_b128 v230, v[172:175] offset:1024
    s_waitcnt lgkmcnt(0)
    s_barrier
    ds_read_b128 v[80:83], v224 offset:0
    ds_read_b128 v[84:87], v224 offset:1024
    s_waitcnt lgkmcnt(1)
    v_pk_add_f32 v[160:161], v[160:161], v[80:81] op_sel:[0,0] op_sel_hi:[1,1]
    v_pk_add_f32 v[162:163], v[162:163], v[82:83] op_sel:[0,0] op_sel_hi:[1,1]
    s_waitcnt lgkmcnt(0)
    v_pk_add_f32 v[164:165], v[164:165], v[84:85] op_sel:[0,0] op_sel_hi:[1,1]
    v_pk_add_f32 v[166:167], v[166:167], v[86:87] op_sel:[0,0] op_sel_hi:[1,1]
    v_pk_fma_f32 v[160:161], v[160:161], v[200:201], v[192:193] op_sel:[0,0,0] op_sel_hi:[1,1,1]
    v_pk_fma_f32 v[162:163], v[162:163], v[202:203], v[194:195] op_sel:[0,0,0] op_sel_hi:[1,1,1]
    v_pk_fma_f32 v[164:165], v[164:165], v[204:205], v[196:197] op_sel:[0,0,0] op_sel_hi:[1,1,1]
    v_pk_fma_f32 v[166:167], v[166:167], v[206:207], v[198:199] op_sel:[0,0,0] op_sel_hi:[1,1,1]
    v_cvt_pk_bf16_f32 v160, v160, v161
    v_cvt_pk_bf16_f32 v161, v162, v163
    v_cvt_pk_bf16_f32 v162, v164, v165
    v_cvt_pk_bf16_f32 v163, v166, v167
    s_nop 0
    v_permlane32_swap_b32 v160, v162
    v_permlane32_swap_b32 v161, v163
    buffer_store_dwordx4 v[160:163], v234, s[72:75], s55 offen
L_fin:
L_end:
    s_endpgm
L_typec:
    v_mov_b32 v240, s79
    v_mul_f32 v128, v249, v128
    v_mul_f32 v129, v249, v129
    v_mul_f32 v130, v249, v130
    v_mul_f32 v131, v249, v131
    v_mul_f32 v132, v249, v132
    v_mul_f32 v133, v249, v133
    v_mul_f32 v134, v249, v134
    v_mul_f32 v135, v249, v135
    v_mul_f32 v136, v249, v136
    v_mul_f32 v137, v249, v137
    v_mul_f32 v138, v249, v138
    v_mul_f32 v139, v249, v139
    v_mul_f32 v140, v249, v140
    v_mul_f32 v141, v249, v141
    v_mul_f32 v142, v249, v142
    v_mul_f32 v143, v249, v143
    v_cvt_pk_bf16_f32 v224, v128, v129
    v_cvt_pk_bf16_f32 v225, v130, v131
    v_cvt_pk_bf16_f32 v226, v132, v133
    v_cvt_pk_bf16_f32 v227, v134, v135
    v_cvt_pk_bf16_f32 v228, v136, v137
    v_cvt_pk_bf16_f32 v229, v138, v139
    v_cvt_pk_bf16_f32 v230, v140, v141
    v_cvt_pk_bf16_f32 v231, v142, v143
    v_cndmask_b32 v224, v224, v240, s[84:85]
    v_cndmask_b32 v225, v225, 0, s[84:85]
    v_cndmask_b32 v230, v230, v240, s[32:33]
    v_cndmask_b32 v231, v231, 0, s[32:33]
    v_permlane32_swap_b32 v224, v226
    v_permlane32_swap_b32 v225, v227
    v_permlane32_swap_b32 v228, v230
    v_permlane32_swap_b32 v229, v231
    buffer_store_dwordx4 v[224:227], v2, s[40:43], s76 offen offset:0 sc1
    buffer_store_dwordx4 v[228:231], v2, s[40:43], s76 offen offset:1024 sc1
    v_mov_b32 v240, s80
    v_mul_f32 v144, v249, v144
    v_mul_f32 v145, v249, v145
    v_mul_f32 v146, v249, v146
    v_mul_f32 v147, v249, v147
    v_mul_f32 v148, v249, v148
    v_mul_f32 v149, v249, v149
    v_mul_f32 v150, v249, v150
    v_mul_f32 v151, v249, v151
    v_mul_f32 v152, v249, v152
    v_mul_f32 v153, v249, v153
    v_mul_f32 v154, v249, v154
    v_mul_f32 v155, v249, v155
    v_mul_f32 v156, v249, v156
    v_mul_f32 v157, v249, v157
    v_mul_f32 v158, v249, v158
    v_mul_f32 v159, v249, v159
    v_cvt_pk_bf16_f32 v232, v144, v145
    v_cvt_pk_bf16_f32 v233, v146, v147
    v_cvt_pk_bf16_f32 v234, v148, v149
    v_cvt_pk_bf16_f32 v235, v150, v151
    v_cvt_pk_bf16_f32 v236, v152, v153
    v_cvt_pk_bf16_f32 v237, v154, v155
    v_cvt_pk_bf16_f32 v238, v156, v157
    v_cvt_pk_bf16_f32 v239, v158, v159
    v_cndmask_b32 v232, v232, v240, s[84:85]
    v_cndmask_b32 v233, v233, 0, s[84:85]
    v_cndmask_b32 v238, v238, v240, s[32:33]
    v_cndmask_b32 v239, v239, 0, s[32:33]
    v_permlane32_swap_b32 v232, v234
    v_permlane32_swap_b32 v233, v235
    v_permlane32_swap_b32 v236, v238
    v_permlane32_swap_b32 v237, v239
    buffer_store_dwordx4 v[232:235], v2, s[40:43], s77 offen offset:0 sc1
    buffer_store_dwordx4 v[236:239], v2, s[40:43], s77 offen offset:1024 sc1
    v_mov_b32 v240, s81
    v_mul_f32 v160, v249, v160
    v_mul_f32 v161, v249, v161
    v_mul_f32 v162, v249, v162
    v_mul_f32 v163, v249, v163
    v_mul_f32 v164, v249, v164
    v_mul_f32 v165, v249, v165
    v_mul_f32 v166, v249, v166
    v_mul_f32 v167, v249, v167
    v_mul_f32 v168, v249, v168
    v_mul_f32 v169, v249, v169
    v_mul_f32 v170, v249, v170
    v_mul_f32 v171, v249, v171
    v_mul_f32 v172, v249, v172
    v_mul_f32 v173, v249, v173
    v_mul_f32 v174, v249, v174
    v_mul_f32 v175, v249, v175
    v_cvt_pk_bf16_f32 v224, v160, v161
    v_cvt_pk_bf16_f32 v225, v162, v163
    v_cvt_pk_bf16_f32 v226, v164, v165
    v_cvt_pk_bf16_f32 v227, v166, v167
    v_cvt_pk_bf16_f32 v228, v168, v169
    v_cvt_pk_bf16_f32 v229, v170, v171
    v_cvt_pk_bf16_f32 v230, v172, v173
    v_cvt_pk_bf16_f32 v231, v174, v175
    v_cndmask_b32 v224, v224, v240, s[84:85]
    v_cndmask_b32 v225, v225, 0, s[84:85]
    v_cndmask_b32 v230, v230, v240, s[32:33]
    v_cndmask_b32 v231, v231, 0, s[32:33]
    v_permlane32_swap_b32 v224, v226
    v_permlane32_swap_b32 v225, v227
    v_permlane32_swap_b32 v228, v230
    v_permlane32_swap_b32 v229, v231
    buffer_store_dwordx4 v[224:227], v2, s[40:43], s78 offen offset:0 sc1
    buffer_store_dwordx4 v[228:231], v2, s[40:43], s78 offen offset:1024 sc1
    s_waitcnt lgkmcnt(4)
    v_mfma_f32_32x32x16_bf16 v[176:191], v[212:215], v[16:19], v[176:191]
    ds_read_b64_tr_b16 v[208:209], v15 offset:18432
    ds_read_b64_tr_b16 v[210:211], v15 offset:18944
    s_waitcnt lgkmcnt(4)
    v_mfma_f32_32x32x16_bf16 v[192:207], v[216:219], v[16:19], v[192:207]
    ds_read_b64_tr_b16 v[212:213], v15 offset:12288
    ds_read_b64_tr_b16 v[214:215], v15 offset:12800
    s_waitcnt lgkmcnt(4)
    v_mfma_f32_32x32x16_bf16 v[176:191], v[220:223], v[20:23], v[176:191]
    ds_read_b64_tr_b16 v[216:217], v15 offset:20480
    ds_read_b64_tr_b16 v[218:219], v15 offset:20992
    s_waitcnt lgkmcnt(4)
    v_mfma_f32_32x32x16_bf16 v[192:207], v[208:211], v[20:23], v[192:207]
    ds_read_b64_tr_b16 v[220:221], v15 offset:14336
    ds_read_b64_tr_b16 v[222:223], v15 offset:14848
    s_waitcnt lgkmcnt(4)
    v_mfma_f32_32x32x16_bf16 v[176:191], v[212:215], v[24:27], v[176:191]
    ds_read_b64_tr_b16 v[208:209], v15 offset:22528
    ds_read_b64_tr_b16 v[210:211], v15 offset:23040
    s_waitcnt lgkmcnt(4)
    v_mfma_f32_32x32x16_bf16 v[192:207], v[216:219], v[24:27], v[192:207]
    s_waitcnt vmcnt(16)
    s_barrier
    ds_read_b64_tr_b16 v[212:213], v15 offset:24576
    ds_read_b64_tr_b16 v[214:215], v15 offset:25088
    v_lshrrev_b32 v20, 2, v1
    v_and_b32 v20, 12, v20
    s_waitcnt lgkmcnt(4)
    v_mfma_f32_32x32x16_bf16 v[176:191], v[220:223], v[28:31], v[176:191]
    ds_read_b64_tr_b16 v[216:217], v13 offset:0
    ds_read_b64_tr_b16 v[218:219], v13 offset:512
    s_add_u32 m0, s6, 40960
    s_nop 0
    buffer_load_dwordx4 v6, s[64:67], s89 offen lds
    v_and_b32 v21, 15, v1
    s_waitcnt lgkmcnt(4)
    v_mfma_f32_32x32x16_bf16 v[192:207], v[208:211], v[28:31], v[192:207]
    ds_read_b64_tr_b16 v[220:221], v15 offset:26624
    ds_read_b64_tr_b16 v[222:223], v15 offset:27136
    v_sub_u32 v20, v21, v20
    s_waitcnt lgkmcnt(4)
    v_mfma_f32_32x32x16_bf16 v[176:191], v[212:215], v[112:115], v[176:191]
    ds_read_b64_tr_b16 v[208:209], v13 offset:2048
    ds_read_b64_tr_b16 v[210:211], v13 offset:2560
    s_add_u32 m0, s6, 49152
    s_add_u32 s89, s89, 57344
    buffer_load_dwordx4 v6, s[64:67], s89 offen lds
    v_mov_b32 v21, 4048155338
    s_waitcnt lgkmcnt(4)
    v_mfma_f32_32x32x16_bf16 v[192:207], v[216:219], v[112:115], v[192:207]
    ds_read_b64_tr_b16 v[212:213], v15 offset:28672
    ds_read_b64_tr_b16 v[214:215], v15 offset:29184
    v_cmp_gt_i32 vcc, 0, v20
    s_nop 1
    v_cndmask_b32 v132, v21, 0, vcc
    v_cndmask_b32 v128, 0, v21, vcc
    s_waitcnt lgkmcnt(4)
    v_mfma_f32_32x32x16_bf16 v[176:191], v[220:223], v[116:119], v[176:191]
    ds_read_b64_tr_b16 v[216:217], v13 offset:4096
    ds_read_b64_tr_b16 v[218:219], v13 offset:4608
    s_add_u32 m0, s6, 57344
    s_add_u32 s89, s89, 57344
    buffer_load_dwordx4 v6, s[64:67], s89 offen lds
    v_cmp_gt_i32 vcc, 1, v20
    s_nop 1
    v_cndmask_b32 v133, v21, 0, vcc
    v_cndmask_b32 v129, 0, v21, vcc
    s_waitcnt lgkmcnt(4)
    v_mfma_f32_32x32x16_bf16 v[192:207], v[208:211], v[116:119], v[192:207]
    ds_read_b64_tr_b16 v[220:221], v15 offset:30720
    ds_read_b64_tr_b16 v[222:223], v15 offset:31232
    v_cmp_gt_i32 vcc, 2, v20
    s_nop 1
    v_cndmask_b32 v134, v21, 0, vcc
    v_cndmask_b32 v130, 0, v21, vcc
    s_waitcnt lgkmcnt(4)
    v_mfma_f32_32x32x16_bf16 v[176:191], v[212:215], v[120:123], v[176:191]
    ds_read_b64_tr_b16 v[208:209], v13 offset:6144
    ds_read_b64_tr_b16 v[210:211], v13 offset:6656
    v_cmp_gt_i32 vcc, 3, v20
    s_nop 1
    v_cndmask_b32 v135, v21, 0, vcc
    v_cndmask_b32 v131, 0, v21, vcc
    s_waitcnt lgkmcnt(4)
    v_mfma_f32_32x32x16_bf16 v[192:207], v[216:219], v[120:123], v[192:207]
    s_waitcnt vmcnt(17)
    s_barrier
    ds_read_b64_tr_b16 v[212:213], v13 offset:8192
    ds_read_b64_tr_b16 v[214:215], v13 offset:8704
    s_waitcnt lgkmcnt(4)
    v_mfma_f32_32x32x16_bf16 v[176:191], v[220:223], v[124:127], v[176:191]
    ds_read_b64_tr_b16 v[216:217], v14 offset:0
    ds_read_b64_tr_b16 v[218:219], v14 offset:512
    s_add_u32 m0, s6, 0
    s_add_u32 s89, s89, 57344
    buffer_load_dwordx4 v6, s[64:67], s89 offen lds
    s_waitcnt lgkmcnt(4)
    v_mfma_f32_32x32x16_bf16 v[192:207], v[208:211], v[124:127], v[192:207]
    ds_read_b64_tr_b16 v[220:221], v13 offset:10240
    ds_read_b64_tr_b16 v[222:223], v13 offset:10752
    s_waitcnt lgkmcnt(4)
    v_mfma_f32_32x32x16_bf16 v[176:191], v[212:215], v[32:35], v[176:191]
    ds_read_b64_tr_b16 v[208:209], v14 offset:2048
    ds_read_b64_tr_b16 v[210:211], v14 offset:2560
    s_waitcnt lgkmcnt(4)
    v_mfma_f32_32x32x16_bf16 v[192:207], v[216:219], v[32:35], v[192:207]
    ds_read_b64_tr_b16 v[212:213], v13 offset:12288
    ds_read_b64_tr_b16 v[214:215], v13 offset:12800
    s_waitcnt lgkmcnt(4)
    v_mfma_f32_32x32x16_bf16 v[176:191], v[220:223], v[36:39], v[176:191]
    ds_read_b64_tr_b16 v[216:217], v14 offset:4096
    ds_read_b64_tr_b16 v[218:219], v14 offset:4608
    s_waitcnt lgkmcnt(4)
    v_mfma_f32_32x32x16_bf16 v[192:207], v[208:211], v[36:39], v[192:207]
    ds_read_b64_tr_b16 v[220:221], v13 offset:14336
    ds_read_b64_tr_b16 v[222:223], v13 offset:14848
    s_waitcnt lgkmcnt(4)
    v_mfma_f32_32x32x16_bf16 v[176:191], v[212:215], v[40:43], v[176:191]
    ds_read_b64_tr_b16 v[208:209], v14 offset:6144
    ds_read_b64_tr_b16 v[210:211], v14 offset:6656
    s_waitcnt lgkmcnt(4)
    v_mfma_f32_32x32x16_bf16 v[192:207], v[216:219], v[40:43], v[192:207]
    s_waitcnt vmcnt(4)
    s_barrier
    ds_read_b64_tr_b16 v[212:213], v14 offset:8192
    ds_read_b64_tr_b16 v[214:215], v14 offset:8704
    s_cmp_lg_u32 s3, 0
    s_cbranch_scc1 L_sig_15
    v_mov_b32 v17, s7
    s_mov_b64 exec, 1
    s_add_u32 s97, s83, 0
    buffer_store_dword v17, off, s[40:43], s97 sc1
    s_mov_b64 exec, -1
L_sig_15:
    s_cmp_lg_u32 s3, 0
    s_cbranch_scc1 L_sig_16
    v_mov_b32 v17, s7
    s_mov_b64 exec, 1
    s_add_u32 s97, s83, 4096
    buffer_store_dword v17, off, s[40:43], s97 sc1
    s_mov_b64 exec, -1
L_sig_16:
    s_waitcnt lgkmcnt(4)
    v_mfma_f32_32x32x16_bf16 v[176:191], v[220:223], v[44:47], v[176:191]
    ds_read_b64_tr_b16 v[216:217], v14 offset:16384
    ds_read_b64_tr_b16 v[218:219], v14 offset:16896
    s_add_u32 m0, s6, 8192
    s_add_u32 s89, s89, 57344
    buffer_load_dwordx4 v6, s[64:67], s89 offen lds
    s_waitcnt lgkmcnt(4)
    v_mfma_f32_32x32x16_bf16 v[192:207], v[208:211], v[44:47], v[192:207]
    ds_read_b64_tr_b16 v[220:221], v14 offset:10240
    ds_read_b64_tr_b16 v[222:223], v14 offset:10752
    s_waitcnt lgkmcnt(4)
    v_mfma_f32_32x32x16_bf16 v[176:191], v[212:215], v[48:51], v[176:191]
    ds_read_b64_tr_b16 v[208:209], v14 offset:18432
    ds_read_b64_tr_b16 v[210:211], v14 offset:18944
    s_add_u32 m0, s6, 65536
    s_add_u32 s89, s89, 57344
    buffer_load_dwordx4 v6, s[64:67], s89 offen lds
    s_waitcnt lgkmcnt(4)
    v_mfma_f32_32x32x16_bf16 v[192:207], v[216:219], v[48:51], v[192:207]
    ds_read_b64_tr_b16 v[212:213], v14 offset:12288
    ds_read_b64_tr_b16 v[214:215], v14 offset:12800
    s_waitcnt lgkmcnt(4)
    v_mfma_f32_32x32x16_bf16 v[176:191], v[220:223], v[52:55], v[176:191]
    ds_read_b64_tr_b16 v[216:217], v14 offset:20480
    ds_read_b64_tr_b16 v[218:219], v14 offset:20992
    s_add_u32 s97, s89, 688128
    buffer_load_dwordx4 v[112:115], v6, s[64:67], s97 offen
    s_waitcnt lgkmcnt(4)
    v_mfma_f32_32x32x16_bf16 v[192:207], v[208:211], v[52:55], v[192:207]
    ds_read_b64_tr_b16 v[220:221], v14 offset:14336
    ds_read_b64_tr_b16 v[222:223], v14 offset:14848
    s_waitcnt lgkmcnt(4)
    v_mfma_f32_32x32x16_bf16 v[176:191], v[212:215], v[56:59], v[176:191]
    ds_read_b64_tr_b16 v[208:209], v14 offset:22528
    ds_read_b64_tr_b16 v[210:211], v14 offset:23040
    s_waitcnt lgkmcnt(4)
    v_mfma_f32_32x32x16_bf16 v[192:207], v[216:219], v[56:59], v[192:207]
    s_barrier
    ds_read_b64_tr_b16 v[212:213], v13 offset:16384
    ds_read_b64_tr_b16 v[214:215], v13 offset:16896
    s_waitcnt lgkmcnt(4)
    v_mfma_f32_32x32x16_bf16 v[176:191], v[220:223], v[60:63], v[176:191]
    ds_read_b64_tr_b16 v[216:217], v13 offset:24576
    ds_read_b64_tr_b16 v[218:219], v13 offset:25088
    s_add_u32 m0, s6, 73728
    s_add_u32 s89, s89, 57344
    buffer_load_dwordx4 v6, s[64:67], s89 offen lds
    s_waitcnt lgkmcnt(4)
    v_mfma_f32_32x32x16_bf16 v[192:207], v[208:211], v[60:63], v[192:207]
    ds_read_b64_tr_b16 v[220:221], v13 offset:18432
    ds_read_b64_tr_b16 v[222:223], v13 offset:18944
    s_waitcnt lgkmcnt(4)
    v_mfma_f32_32x32x16_bf16 v[176:191], v[212:215], v[64:67], v[176:191]
    ds_read_b64_tr_b16 v[208:209], v13 offset:26624
    ds_read_b64_tr_b16 v[210:211], v13 offset:27136
    s_add_u32 m0, s6, 81920
    s_add_u32 s89, s89, 57344
    buffer_load_dwordx4 v6, s[64:67], s89 offen lds
    s_waitcnt lgkmcnt(4)
    v_mfma_f32_32x32x16_bf16 v[192:207], v[216:219], v[64:67], v[192:207]
    ds_read_b64_tr_b16 v[212:213], v13 offset:20480
    ds_read_b64_tr_b16 v[214:215], v13 offset:20992
    s_waitcnt lgkmcnt(4)
    v_mfma_f32_32x32x16_bf16 v[176:191], v[220:223], v[68:71], v[176:191]
    ds_read_b64_tr_b16 v[216:217], v13 offset:28672
    ds_read_b64_tr_b16 v[218:219], v13 offset:29184
    s_add_u32 s97, s89, 630784
    buffer_load_dwordx4 v[116:119], v6, s[64:67], s97 offen
    s_waitcnt lgkmcnt(4)
    v_mfma_f32_32x32x16_bf16 v[192:207], v[208:211], v[68:71], v[192:207]
    ds_read_b64_tr_b16 v[220:221], v13 offset:22528
    ds_read_b64_tr_b16 v[222:223], v13 offset:23040
    s_waitcnt lgkmcnt(4)
    v_mfma_f32_32x32x16_bf16 v[176:191], v[212:215], v[72:75], v[176:191]
    ds_read_b64_tr_b16 v[208:209], v13 offset:30720
    ds_read_b64_tr_b16 v[210:211], v13 offset:31232
    s_waitcnt lgkmcnt(4)
    v_mfma_f32_32x32x16_bf16 v[192:207], v[216:219], v[72:75], v[192:207]
    s_barrier
    ds_read_b64_tr_b16 v[212:213], v14 offset:24576
    ds_read_b64_tr_b16 v[214:215], v14 offset:25088
    s_mov_b32 s97, 0x0b0b0909
    v_perm_b32 v60, v129, v128, s97
    v_perm_b32 v61, v131, v130, s97
    s_waitcnt lgkmcnt(4)
    v_mfma_f32_32x32x16_bf16 v[176:191], v[220:223], v[76:79], v[176:191]
    ds_read_b64_tr_b16 v[216:217], v14 offset:32768
    ds_read_b64_tr_b16 v[218:219], v14 offset:33280
    s_add_u32 m0, s6, 16384
    s_add_u32 s89, s89, 57344
    buffer_load_dwordx4 v6, s[64:67], s89 offen lds
    s_waitcnt lgkmcnt(4)
    v_mfma_f32_32x32x16_bf16 v[192:207], v[208:211], v[76:79], v[192:207]
    ds_read_b64_tr_b16 v[220:221], v14 offset:26624
    ds_read_b64_tr_b16 v[222:223], v14 offset:27136
    s_waitcnt lgkmcnt(4)
    v_mfma_f32_32x32x16_bf16 v[176:191], v[212:215], v[80:83], v[176:191]
    ds_read_b64_tr_b16 v[208:209], v14 offset:34816
    ds_read_b64_tr_b16 v[210:211], v14 offset:35328
    s_add_u32 m0, s6, 24576
    s_add_u32 s89, s89, 57344
    buffer_load_dwordx4 v6, s[64:67], s89 offen lds
    s_waitcnt lgkmcnt(4)
    v_mfma_f32_32x32x16_bf16 v[192:207], v[216:219], v[80:83], v[192:207]
    ds_read_b64_tr_b16 v[212:213], v14 offset:28672
    ds_read_b64_tr_b16 v[214:215], v14 offset:29184
    s_waitcnt lgkmcnt(4)
    v_mfma_f32_32x32x16_bf16 v[176:191], v[220:223], v[84:87], v[176:191]
    ds_read_b64_tr_b16 v[216:217], v14 offset:36864
    ds_read_b64_tr_b16 v[218:219], v14 offset:37376
    s_add_u32 s97, s89, 573440
    buffer_load_dwordx4 v[120:123], v6, s[64:67], s97 offen
    s_waitcnt lgkmcnt(4)
    v_mfma_f32_32x32x16_bf16 v[192:207], v[208:211], v[84:87], v[192:207]
    ds_read_b64_tr_b16 v[220:221], v14 offset:30720
    ds_read_b64_tr_b16 v[222:223], v14 offset:31232
    s_waitcnt lgkmcnt(4)
    v_mfma_f32_32x32x16_bf16 v[176:191], v[212:215], v[88:91], v[176:191]
    ds_read_b64_tr_b16 v[208:209], v14 offset:38912
    ds_read_b64_tr_b16 v[210:211], v14 offset:39424
    s_waitcnt lgkmcnt(4)
    v_mfma_f32_32x32x16_bf16 v[192:207], v[216:219], v[88:91], v[192:207]
    s_barrier
    ds_read_b64_tr_b16 v[212:213], v14 offset:40960
    ds_read_b64_tr_b16 v[214:215], v14 offset:41472
    buffer_load_dword v16, v8, s[40:43], 0 offen sc1
    s_waitcnt lgkmcnt(4)
    v_mfma_f32_32x32x16_bf16 v[176:191], v[220:223], v[92:95], v[176:191]
    ds_read_b64_tr_b16 v[216:217], v13 offset:32768
    ds_read_b64_tr_b16 v[218:219], v13 offset:33280
    s_add_u32 m0, s6, 90112
    s_add_u32 s89, s89, 57344
    buffer_load_dwordx4 v6, s[64:67], s89 offen lds
    s_waitcnt lgkmcnt(4)
    v_mfma_f32_32x32x16_bf16 v[192:207], v[208:211], v[92:95], v[192:207]
    ds_read_b64_tr_b16 v[220:221], v14 offset:43008
    ds_read_b64_tr_b16 v[222:223], v14 offset:43520
    s_waitcnt lgkmcnt(4)
    v_mfma_f32_32x32x16_bf16 v[176:191], v[212:215], v[96:99], v[176:191]
    ds_read_b64_tr_b16 v[208:209], v13 offset:34816
    ds_read_b64_tr_b16 v[210:211], v13 offset:35328
    s_waitcnt lgkmcnt(4)
    v_mfma_f32_32x32x16_bf16 v[192:207], v[216:219], v[96:99], v[192:207]
    ds_read_b64_tr_b16 v[212:213], v14 offset:45056
    ds_read_b64_tr_b16 v[214:215], v14 offset:45568
    s_add_u32 m0, s6, 98304
    s_add_u32 s89, s89, 57344
    buffer_load_dwordx4 v6, s[64:67], s89 offen lds
    s_waitcnt lgkmcnt(4)
    v_mfma_f32_32x32x16_bf16 v[176:191], v[220:223], v[100:103], v[176:191]
    ds_read_b64_tr_b16 v[216:217], v13 offset:36864
    ds_read_b64_tr_b16 v[218:219], v13 offset:37376
    s_waitcnt lgkmcnt(4)
    v_mfma_f32_32x32x16_bf16 v[192:207], v[208:211], v[100:103], v[192:207]
    ds_read_b64_tr_b16 v[220:221], v14 offset:47104
    ds_read_b64_tr_b16 v[222:223], v14 offset:47616
    s_waitcnt lgkmcnt(4)
    v_mfma_f32_32x32x16_bf16 v[176:191], v[212:215], v[104:107], v[176:191]
    ds_read_b64_tr_b16 v[208:209], v13 offset:38912
    ds_read_b64_tr_b16 v[210:211], v13 offset:39424
    s_waitcnt vmcnt(2)
    v_cmp_ne_u32 vcc, s7, v16
    s_nop 0
    s_cmp_lg_u64 vcc, 0
    s_cbranch_scc1 L_spin_13
L_back_14:
    buffer_load_dwordx4 v[252:255], v3, s[40:43], s47 offen sc1
    s_waitcnt lgkmcnt(4)
    v_mfma_f32_32x32x16_bf16 v[192:207], v[216:219], v[104:107], v[192:207]
    s_barrier
    s_add_u32 m0, s6, 114688
    s_nop 0
    buffer_load_dwordx4 v2, s[40:43], s44 offen sc1 lds
    s_waitcnt lgkmcnt(2)
    v_mfma_f32_32x32x16_bf16 v[176:191], v[220:223], v[108:111], v[176:191]
    s_add_u32 m0, s6, 122880
    s_nop 0
    buffer_load_dwordx4 v2, s[40:43], s45 offen sc1 lds
    s_waitcnt lgkmcnt(0)
    v_mfma_f32_32x32x16_bf16 v[192:207], v[208:211], v[108:111], v[192:207]
    s_add_u32 m0, s6, 131072
    s_nop 0
    buffer_load_dwordx4 v2, s[40:43], s46 offen sc1 lds
    s_nop 1
    s_branch L_join
L_noout:
    s_waitcnt vmcnt(0) lgkmcnt(0)
    s_barrier
    s_cmp_lg_u32 s3, 0
    s_cbranch_scc1 L_sig_32
    v_mov_b32 v192, s7
    s_mov_b64 exec, 1
    buffer_store_dword v192, off, s[40:43], s52 sc1
    s_mov_b64 exec, -1
L_sig_32:
    s_branch L_fin
L_spin_7:
    s_mov_b32 s96, 0
L_spin_7_l:
    buffer_load_dword v226, v8, s[40:43], 0 offen sc1
    s_add_u32 s96, s96, 1
    s_cmp_gt_u32 s96, 0x4000
    s_cbranch_scc1 L_spin_7_x
    s_waitcnt vmcnt(0)
    v_cmp_ne_u32 vcc, s7, v226
    s_nop 1
    s_cmp_lg_u64 vcc, 0
    s_cbranch_scc1 L_spin_7_l
L_spin_7_x:
    s_waitcnt vmcnt(0)
    s_branch L_back_8
L_spin_9:
    s_mov_b32 s96, 0
L_spin_9_l:
    buffer_load_dword v16, v8, s[40:43], 0 offen sc1
    s_add_u32 s96, s96, 1
    s_cmp_gt_u32 s96, 0x4000
    s_cbranch_scc1 L_spin_9_x
    s_waitcnt vmcnt(0)
    v_cmp_ne_u32 vcc, s7, v16
    s_nop 1
    s_cmp_lg_u64 vcc, 0
    s_cbranch_scc1 L_spin_9_l
L_spin_9_x:
    s_waitcnt vmcnt(0)
    s_branch L_back_10
L_spin_13:
    s_mov_b32 s96, 0
L_spin_13_l:
    buffer_load_dword v16, v8, s[40:43], 0 offen sc1
    s_add_u32 s96, s96, 1
    s_cmp_gt_u32 s96, 0x4000
    s_cbranch_scc1 L_spin_13_x
    s_waitcnt vmcnt(0)
    v_cmp_ne_u32 vcc, s7, v16
    s_nop 1
    s_cmp_lg_u64 vcc, 0
    s_cbranch_scc1 L_spin_13_l
L_spin_13_x:
    s_waitcnt vmcnt(0)
    s_branch L_back_14
L_spin_18:
    s_mov_b32 s96, 0
L_spin_18_l:
    buffer_load_dword v18, v4, s[40:43], 0 offen sc1
    s_add_u32 s96, s96, 1
    s_cmp_gt_u32 s96, 0x4000
    s_cbranch_scc1 L_spin_18_x
    s_waitcnt vmcnt(0)
    v_cmp_ne_u32 vcc, s7, v18
    s_nop 1
    s_cmp_lg_u64 vcc, 0
    s_cbranch_scc1 L_spin_18_l
L_spin_18_x:
    s_waitcnt vmcnt(0)
    s_branch L_back_19
L_spin_21:
    s_mov_b32 s96, 0
L_spin_21_l:
    buffer_load_dword v206, v4, s[40:43], s100 offen sc1
    s_add_u32 s96, s96, 1
    s_cmp_gt_u32 s96, 0x4000
    s_cbranch_scc1 L_spin_21_x
    s_waitcnt vmcnt(0)
    v_cmp_ne_u32 vcc, s7, v206
    s_nop 1
    s_cmp_lg_u64 vcc, 0
    s_cbranch_scc1 L_spin_21_l
L_spin_21_x:
    s_waitcnt vmcnt(0)
    s_branch L_back_22
L_spin_30:
    s_mov_b32 s96, 0
L_spin_30_l:
    buffer_load_dword v193, v4, s[40:43], s95 offen sc1
    s_add_u32 s96, s96, 1
    s_cmp_gt_u32 s96, 0x4000
    s_cbranch_scc1 L_spin_30_x
    s_waitcnt vmcnt(0)
    v_cmp_ne_u32 vcc, s7, v193
    s_nop 1
    s_cmp_lg_u64 vcc, 0
    s_cbranch_scc1 L_spin_30_l
L_spin_30_x:
    s_waitcnt vmcnt(0)
    s_branch L_back_31
L_code_end:
    s_endpgm
.section .rodata,"a"
.p2align 6
.amdhsa_kernel recurrent_scan__sliding_block__glu_gated_swiglu__prompt_kernel
  .amdhsa_next_free_vgpr 256
  .amdhsa_next_free_sgpr 102
  .amdhsa_accum_offset 256
  .amdhsa_group_segment_fixed_size 0
  .amdhsa_kernarg_size 80
  .amdhsa_user_sgpr_count 2
  .amdhsa_user_sgpr_kernarg_segment_ptr 1
  .amdhsa_system_sgpr_workgroup_id_x 1
.end_amdhsa_kernel
```
